```python
import torch

def _softmax(x, axis=-1):
    return torch.softmax(x, dim=axis)
def _gelu(x):
    return torch.nn.functional.gelu(x, approximate="tanh")
def _silu(x):
    return torch.nn.functional.silu(x)
def _sigmoid(x):
    return torch.sigmoid(x)
def _layernorm(x, axis=-1, eps=1e-5):
    m = x.mean(dim=axis, keepdim=True)
    v = x.var(dim=axis, keepdim=True, unbiased=False)
    return (x - m) / torch.sqrt(v + eps)
def _scatter_add(tgt, idx, src, axis=0):
    return tgt.clone().index_add_(axis, idx, src)
def _segment_sum(src, seg, n):
    out = torch.zeros((n,) + src.shape[1:], dtype=src.dtype)
    return out.index_add_(0, seg, src)
def _pad(x, pw):
    flat = tuple(v for pair in reversed(pw) for v in pair)
    return torch.nn.functional.pad(x, flat)

kernel_name = 'standalone__edge_featured_mpnn_egc__graph'

def setup_inputs():

    _w = (lambda a: (lambda t: t.to(torch.bfloat16) if t.is_floating_point() else t)(torch.as_tensor(a)))
    N, deg, D, De = 12500, 64, 64, max(4, 1)
    E = N * deg
    return {
        "x": _w((lambda *s: torch.randn(*s, dtype=torch.bfloat16) * 0.2)(N, D)),
        "e_attr": _w((lambda *s: torch.randn(*s, dtype=torch.bfloat16) * 0.2)(E, De)),
        "src": _w((lambda lo, hi, *s: torch.randint(lo, hi, s))(0, N, E).to(torch.int64)),
        "dst": _w((lambda lo, hi, *s: torch.randint(lo, hi, s))(0, N, E).to(torch.int64)),
        "u_w": _w((lambda *s: torch.randn(*s, dtype=torch.bfloat16) * 0.05)(D, D)),
        "v_w": _w((lambda *s: torch.randn(*s, dtype=torch.bfloat16) * 0.05)(D, D)),
        "g_w": _w((lambda *s: torch.randn(*s, dtype=torch.bfloat16) * 0.2)(2 * D + De, D)),
    }

def reference(x, e_attr, src, dst, u_w, v_w, g_w):
    N, D = x.shape
    g_in = torch.concatenate([x[dst], x[src], e_attr], axis=-1)
    eta = _sigmoid(g_in @ g_w)
    hv = x @ v_w
    msg = eta * hv[src]
    agg = _segment_sum(msg, dst, N)
    return _silu(x @ u_w + agg)
```

```asm
; @launch grid=(256,1,1) block=(1024,1,1) lds=153856
.amdgcn_target "amdgcn-amd-amdhsa--gfx950"
.text
.globl standalone__edge_featured_mpnn_egc__graph_kernel
.p2align 8
.type standalone__edge_featured_mpnn_egc__graph_kernel,@function
standalone__edge_featured_mpnn_egc__graph_kernel:
    s_cmp_ge_u32 s2, 256
    s_cbranch_scc1 L_END
    s_load_dwordx8 s[84:91], s[0:1], 0
    s_load_dwordx4 s[4:7], s[0:1], 32
    s_load_dwordx4 s[8:11], s[0:1], 48
    s_load_dwordx4 s[56:59], s[0:1], 64
    v_lshlrev_b32 v26, 4, v0
    v_mov_b32 v28, 0
    v_mov_b32 v29, 0
    v_mov_b32 v30, 0
    v_mov_b32 v31, 0
    v_cmp_gt_u32 vcc, 496, v0
    s_and_saveexec_b64 s[80:81], vcc
    ds_write_b128 v26, v[28:31] offset:56064
    s_mov_b64 exec, s[80:81]
    v_lshlrev_b32 v32, 2, v0
    s_mul_i32 s61, s2, 12544
    s_mul_i32 s63, s2, 3136
    s_sub_u32 s63, 800000, s63
    s_min_u32 s63, s63, 3136
    s_lshl_b32 s64, s63, 2
    v_add_u32 v34, 4096, v32
    v_add_u32 v35, 8192, v32
    v_add_u32 v36, 12288, v32
    v_lshrrev_b32 v27, 6, v0
    v_and_b32 v1, 63, v0
    v_readfirstlane_b32 s72, v27
    s_and_b32 s3, s2, 7
    s_lshl_b32 s3, s3, 5
    s_lshr_b32 s60, s2, 3
    s_add_u32 s3, s3, s60
    s_mul_i32 s62, s2, 25088
    s_lshl_b32 s65, s63, 3
    v_and_b32 v97, 0x50, v0
    v_lshlrev_b32 v96, 1, v97
    v_or_b32 v97, v97, v96
    v_and_b32 v97, 0x60, v97
    v_xor_b32 v97, v97, v26
    v_and_b32 v96, 0x20, v96
    v_lshlrev_b32 v98, 4, v1
    v_xor_b32 v96, v96, v98
    s_lshl_b32 s66, s72, 10
    v_and_b32 v101, 0x1fff, v97
    v_lshrrev_b32 v98, 3, v0
    v_bfe_u32 v99, v98, 1, 3
    v_and_b32 v100, 7, v0
    v_xor_b32 v99, v99, v100
    v_lshlrev_b32 v99, 4, v99
    v_lshl_add_u32 v99, v98, 7, v99
    s_mul_i32 s60, s3, 6272
    v_add_u32 v99, s60, v99
    v_add_u32 v96, 16384, v96
    s_waitcnt lgkmcnt(0)
    s_or_b32 s67, s2, s72
    s_cmp_lg_u32 s67, 0
    s_cbranch_scc1 L_NOTAG
    s_memrealtime s[68:69]
    v_mov_b32 v28, 0
    s_waitcnt lgkmcnt(0)
    s_or_b32 s68, s68, 1
    v_mov_b32 v29, s68
    s_mov_b64 exec, 1
    global_store_dword v28, v29, s[56:57] sc1
    s_mov_b64 exec, -1
L_NOTAG:
    s_add_u32 s20, s90, s61
    s_addc_u32 s21, s91, 0
    s_mov_b32 s22, s64
    s_mov_b32 s23, 0x00020000
    buffer_load_dword v64, v32, s[20:23], 0 offen
    buffer_load_dword v65, v34, s[20:23], 0 offen
    buffer_load_dword v66, v35, s[20:23], 0 offen
    buffer_load_dword v67, v36, s[20:23], 0 offen
    s_mov_b32 s16, s8
    s_mov_b32 s17, s9
    s_mov_b32 s18, 16896
    s_mov_b32 s19, 0x00020000
    s_add_u32 m0, s66, 111872
    s_mov_b32 s12, s84
    s_mov_b32 s13, s85
    s_mov_b32 s14, 1600000
    s_mov_b32 s15, 0x00020000
    buffer_load_dwordx4 v97, s[16:19], 0 offen lds
    s_cmp_lt_u32 s72, 8
    s_cselect_b32 s44, s6, s4
    s_cselect_b32 s45, s7, s5
    s_mov_b32 s46, 8192
    s_mov_b32 s47, 0x00020000
    s_add_u32 m0, s66, 129280
    s_nop 0
    buffer_load_dwordx4 v101, s[44:47], 0 offen lds
    s_cmp_lt_u32 s72, 8
    s_cbranch_scc0 L_D3B
    s_add_u32 m0, s66, 145664
    s_nop 0
    buffer_load_dwordx4 v99, s[12:15], 0 offen lds
    s_branch L_D3C
L_D3B:
    s_mov_b32 m0, 128256
    s_nop 0
    buffer_load_dwordx4 v96, s[16:19], 0 offen lds
L_D3C:
    s_barrier
    s_add_u32 s24, s88, s61
    s_addc_u32 s25, s89, 0
    s_mov_b32 s26, s64
    s_mov_b32 s27, 0x00020000
    buffer_load_dword v68, v32, s[24:27], 0 offen
    buffer_load_dword v69, v34, s[24:27], 0 offen
    buffer_load_dword v70, v35, s[24:27], 0 offen
    buffer_load_dword v71, v36, s[24:27], 0 offen
    s_add_u32 s28, s86, s62
    s_addc_u32 s29, s87, 0
    s_mov_b32 s30, s65
    s_mov_b32 s31, 0x00020000
    v_lshlrev_b32 v92, 3, v0
    v_add_u32 v93, 8192, v92
    v_add_u32 v94, 16384, v92
    v_add_u32 v95, 24576, v92
    buffer_load_dwordx2 v[72:73], v92, s[28:31], 0 offen
    buffer_load_dwordx2 v[74:75], v93, s[28:31], 0 offen
    buffer_load_dwordx2 v[76:77], v94, s[28:31], 0 offen
    buffer_load_dwordx2 v[78:79], v95, s[28:31], 0 offen
    s_mov_b64 s[96:97], s[56:57]
    s_add_u32 s94, s58, 0x0
    s_addc_u32 s95, s59, 0
    s_mov_b32 s52, s10
    s_mov_b32 s53, s11
    s_mov_b32 s54, 1600000
    s_mov_b32 s55, 0x00020000
    s_mul_i32 s84, s2, 13568
    s_add_u32 s32, s94, s84
    s_addc_u32 s33, s95, 0
    s_mov_b32 s34, 13568
    s_mov_b32 s35, 0x00020000
    s_lshl_b32 s84, s84, 1
    s_add_u32 s84, s84, 0x400000
    s_add_u32 s36, s94, s84
    s_addc_u32 s37, s95, 0
    s_mov_b32 s38, 27136
    s_mov_b32 s39, 0x00020000
    s_lshl_b32 s84, s2, 11
    s_add_u32 s84, s84, 0xb00000
    s_add_u32 s40, s94, s84
    s_addc_u32 s41, s95, 0
    s_mov_b32 s42, 2048
    s_mov_b32 s43, 0x00020000
    s_mul_i32 s84, s3, 12544
    s_add_u32 s84, s84, 0xc00000
    s_add_u32 s44, s94, s84
    s_addc_u32 s45, s95, 0
    s_mov_b32 s46, 12544
    s_mov_b32 s47, 0x00020000
    s_add_u32 s48, s94, 0xc00000
    s_addc_u32 s49, s95, 0
    s_or_b32 s49, s49, 0x80000000
    s_mov_b32 s50, 0x400000
    s_mov_b32 s51, 0x00c00000
    s_add_u32 s20, s94, 0x0
    s_addc_u32 s21, s95, 0
    s_mov_b32 s22, 3473408
    s_mov_b32 s23, 0x00020000
    s_add_u32 s24, s94, 0x400000
    s_addc_u32 s25, s95, 0
    s_mov_b32 s26, 6946816
    s_mov_b32 s27, 0x00020000
    v_add_u32 v27, 0, v0
    v_cmp_gt_u32 s[56:57], s63, v27
    v_add_u32 v27, 1024, v0
    v_cmp_gt_u32 s[58:59], s63, v27
    v_add_u32 v27, 2048, v0
    v_cmp_gt_u32 s[60:61], s63, v27
    v_add_u32 v27, 3072, v0
    v_cmp_gt_u32 s[62:63], s63, v27
    s_mov_b32 s78, 0x30000000
    s_mov_b32 s79, 0x30000000
    s_mov_b32 s75, 0
    s_mov_b32 s76, 128
    v_and_b32 v24, 7, v1
    v_lshlrev_b32 v24, 3, v24
    v_and_b32 v27, 56, v1
    s_and_b32 s84, s72, 1
    s_lshl_b32 s84, s84, 7
    s_lshr_b32 s85, s72, 1
    s_add_u32 s84, s84, s85
    v_add_u32 v27, s84, v27
    v_lshlrev_b32 v22, 11, v27
    v_mul_u32_u24 v25, 13568, v27
    v_add_u32 v25, v25, v24
    v_and_b32 v16, 31, v1
    v_lshlrev_b32 v16, 3, v16
    v_add_u32 v17, 86784, v16
    s_and_b32 s84, s72, 3
    s_lshr_b32 s85, s72, 2
    v_and_b32 v12, 15, v1
    v_lshrrev_b32 v13, 4, v1
    v_bfe_u32 v14, v1, 1, 3
    v_xor_b32 v14, v14, v13
    v_lshlrev_b32 v14, 4, v14
    v_lshl_or_b32 v14, v12, 7, v14
    s_lshl_b32 s86, s84, 11
    v_add_u32 v6, s86, v14
    v_bfe_u32 v14, v1, 2, 2
    v_lshl_add_u32 v14, v13, 3, v14
    v_lshlrev_b32 v14, 7, v14
    v_and_b32 v15, 3, v1
    v_lshl_add_u32 v14, v15, 3, v14
    s_lshl_b32 s86, s85, 5
    v_or_b32 v14, s86, v14
    v_and_b32 v15, 24, v1
    v_lshlrev_b32 v15, 2, v15
    v_xor_b32 v14, v14, v15
    v_add_u32 v7, 111872, v14
    s_lshl_b32 s86, s84, 12
    v_lshlrev_b32 v13, 10, v13
    v_add_u32 v13, s86, v13
    s_lshl_b32 s86, s85, 6
    s_add_u32 s86, s86, 67840
    v_lshl_add_u32 v8, v12, 2, v13
    v_add_u32 v8, s86, v8
    s_and_b32 s86, s85, 1
    s_lshl_b32 s86, s86, 7
    s_lshr_b32 s87, s85, 1
    s_lshl_b32 s87, s87, 2
    s_add_u32 s86, s86, s87
    s_add_u32 s86, s86, 86784
    v_lshl_add_u32 v9, v12, 3, v13
    v_add_u32 v9, s86, v9
    v_bfe_u32 v12, v1, 2, 1
    v_lshrrev_b32 v13, 5, v1
    v_xor_b32 v12, v12, v13
    v_and_b32 v13, 1, v1
    v_lshl_or_b32 v12, v12, 1, v13
    v_mov_b32 v13, 0x3f803f80
    v_cmp_eq_u32 vcc, 0, v12
    v_cmp_eq_u32 s[84:85], 1, v12
    s_nop 1
    v_cndmask_b32 v58, 0, v13, vcc
    v_cndmask_b32 v59, 0, v13, s[84:85]
    v_mov_b32 v12, 0
    global_load_dword v10, v12, s[96:97] sc1
    s_add_u32 s28, s94, 0xb00000
    s_addc_u32 s29, s95, 0
    s_mov_b32 s30, 557056
    s_mov_b32 s31, 0x00020000
    s_mov_b32 s84, -49
    v_mov_b32 v27, 4
    s_waitcnt vmcnt(15)
    s_mov_b64 exec, s[56:57]
    v_mul_u32_u24 v28, 21400, v64
    v_lshrrev_b32 v28, 20, v28
    v_mad_i32_i24 v32, v28, s84, v64
    v_lshlrev_b32 v28, 2, v28
    ds_add_rtn_u32 v36, v28, v27 offset:57344
    v_lshlrev_b32 v32, 26, v32
    s_waitcnt vmcnt(14)
    s_mov_b64 exec, s[58:59]
    v_mul_u32_u24 v29, 21400, v65
    v_lshrrev_b32 v29, 20, v29
    v_mad_i32_i24 v33, v29, s84, v65
    v_lshlrev_b32 v29, 2, v29
    ds_add_rtn_u32 v37, v29, v27 offset:57344
    v_lshlrev_b32 v33, 26, v33
    s_waitcnt vmcnt(13)
    s_mov_b64 exec, s[60:61]
    v_mul_u32_u24 v30, 21400, v66
    v_lshrrev_b32 v30, 20, v30
    v_mad_i32_i24 v34, v30, s84, v66
    v_lshlrev_b32 v30, 2, v30
    ds_add_rtn_u32 v38, v30, v27 offset:57344
    v_lshlrev_b32 v34, 26, v34
    s_waitcnt vmcnt(12)
    s_mov_b64 exec, s[62:63]
    s_cbranch_execz L_B1
    v_mul_u32_u24 v31, 21400, v67
    v_lshrrev_b32 v31, 20, v31
    v_mad_i32_i24 v35, v31, s84, v67
    v_lshlrev_b32 v31, 2, v31
    ds_add_rtn_u32 v39, v31, v27 offset:57344
    v_lshlrev_b32 v35, 26, v35
L_B1:
    s_mov_b64 exec, -1
    v_add_u32 v27, 67840, v26
    s_waitcnt vmcnt(9) lgkmcnt(0)
    s_barrier
    s_cmp_lg_u32 s72, 0
    s_cbranch_scc1 L_NOSCAN
    ds_read_b128 v[96:99], v26 offset:57344
    s_waitcnt lgkmcnt(0)
    v_add_u32 v108, 4, v96
    v_and_b32 v108, -8, v108
    v_add_u32 v109, 4, v97
    v_and_b32 v109, -8, v109
    v_add_u32 v110, 4, v98
    v_and_b32 v110, -8, v110
    v_add_u32 v111, 4, v99
    v_and_b32 v111, -8, v111
    v_add_u32 v101, v108, v109
    v_add_u32 v102, v101, v110
    v_add_u32 v103, v102, v111
    v_mov_b32 v104, v103
    s_nop 1
    v_add_u32_dpp v104, v104, v104 row_shr:1 row_mask:0xf bank_mask:0xf
    s_nop 1
    v_add_u32_dpp v104, v104, v104 row_shr:2 row_mask:0xf bank_mask:0xf
    s_nop 1
    v_add_u32_dpp v104, v104, v104 row_shr:4 row_mask:0xf bank_mask:0xf
    s_nop 1
    v_add_u32_dpp v104, v104, v104 row_shr:8 row_mask:0xf bank_mask:0xf
    s_nop 1
    v_add_u32_dpp v104, v104, v104 row_bcast:15 row_mask:0xa bank_mask:0xf
    s_nop 1
    v_add_u32_dpp v104, v104, v104 row_bcast:31 row_mask:0xc bank_mask:0xf
    s_nop 1
    v_readlane_b32 s88, v104, 63
    v_sub_u32 v104, v104, v103
    v_mov_b32 v100, 56328
    v_mov_b32 v105, s88
    ds_write_b32 v100, v105
    v_add_u32 v105, v104, v108
    v_add_u32 v106, v104, v101
    v_add_u32 v107, v104, v102
    ds_write_b128 v26, v[104:107] offset:58368
    v_lshl_or_b32 v108, v96, 16, v104
    v_lshl_or_b32 v109, v97, 16, v105
    v_lshl_or_b32 v110, v98, 16, v106
    v_lshl_or_b32 v111, v99, 16, v107
    ds_write_b128 v26, v[108:111] offset:57344
L_NOSCAN:
    v_add_u32 v12, 145664, v6
    v_xor_b32 v13, 64, v6
    v_add_u32 v13, 145664, v13
    ds_read_b128 v[80:83], v12
    ds_read_b128 v[84:87], v13
    ds_read_b64_tr_b16 v[96:97], v7 offset:8192
    ds_read_b64_tr_b16 v[98:99], v7 offset:8704
    ds_read_b64_tr_b16 v[100:101], v7 offset:12288
    ds_read_b64_tr_b16 v[102:103], v7 offset:12800
    ds_read_b64_tr_b16 v[104:105], v7 offset:17408
    ds_read_b64_tr_b16 v[106:107], v7 offset:17920
    ds_read_b64_tr_b16 v[108:109], v7 offset:21504
    ds_read_b64_tr_b16 v[110:111], v7 offset:22016
    s_mov_b32 s88, 0xbfb8aa3b
    s_mov_b32 s90, 0x7fffffff
    s_mov_b32 s91, 0xffff0000
    s_waitcnt lgkmcnt(4)
    v_mfma_f32_16x16x32_bf16 v[112:115], v[80:83], v[96:99], 0
    v_mfma_f32_16x16x32_bf16 v[112:115], v[84:87], v[100:103], v[112:115]
    s_waitcnt lgkmcnt(0)
    v_mfma_f32_16x16x32_bf16 v[116:119], v[80:83], v[104:107], 0
    v_mfma_f32_16x16x32_bf16 v[116:119], v[84:87], v[108:111], v[116:119]
    s_nop 4
    v_mul_f32 v112, s88, v112
    v_mul_f32 v113, s88, v113
    v_mul_f32 v114, s88, v114
    v_mul_f32 v115, s88, v115
    v_and_b32 v120, s90, v112
    v_and_b32 v121, s90, v113
    v_and_b32 v122, s90, v114
    v_and_b32 v123, s90, v115
    v_mul_f32 v116, 0x4e800000, v116
    v_add_u32 v120, 0x8000, v120
    v_mul_f32 v117, 0x4e800000, v117
    v_add_u32 v121, 0x8000, v121
    v_mul_f32 v118, 0x4e800000, v118
    v_add_u32 v122, 0x8000, v122
    v_mul_f32 v119, 0x4e800000, v119
    v_add_u32 v123, 0x8000, v123
    v_cvt_pk_bf16_f32 v116, v116, v117
    v_cvt_pk_bf16_f32 v118, v118, v119
    v_lshrrev_b32 v117, 16, v116
    v_lshrrev_b32 v119, 16, v118
    v_and_b32 v116, 0xffff, v116
    v_and_b32 v118, 0xffff, v118
    v_sub_u32 v120, v120, v116 clamp
    v_sub_u32 v121, v121, v117 clamp
    v_sub_u32 v122, v122, v118 clamp
    v_sub_u32 v123, v123, v119 clamp
    v_and_or_b32 v120, v120, s91, v116
    v_and_or_b32 v121, v121, s91, v117
    v_and_or_b32 v122, v122, s91, v118
    v_and_or_b32 v123, v123, s91, v119
    v_bfi_b32 v112, s90, v120, v112
    ds_write_b32 v8, v112 offset:0
    v_bfi_b32 v113, s90, v121, v113
    ds_write_b32 v8, v113 offset:256
    v_bfi_b32 v114, s90, v122, v114
    ds_write_b32 v8, v114 offset:512
    v_bfi_b32 v115, s90, v123, v115
    ds_write_b32 v8, v115 offset:768
    s_waitcnt lgkmcnt(0)
    s_barrier
    ds_read_b128 v[112:115], v27
    s_mov_b64 exec, s[56:57]
    ds_read_b32 v28, v28 offset:58368
    s_mov_b64 exec, s[58:59]
    ds_read_b32 v29, v29 offset:58368
    s_mov_b64 exec, s[60:61]
    ds_read_b32 v30, v30 offset:58368
    s_mov_b64 exec, s[62:63]
    ds_read_b32 v31, v31 offset:58368
    s_mov_b64 exec, -1
    s_waitcnt lgkmcnt(4)
    buffer_store_dwordx4 v[112:115], v26, s[44:47], 0 offen sc1
    s_waitcnt vmcnt(6)
    v_lshl_or_b32 v32, v68, 3, v32
    v_lshrrev_b32 v68, 11, v68
    v_lshl_or_b32 v32, v68, 23, v32
    v_lshl_or_b32 v33, v69, 3, v33
    v_lshrrev_b32 v69, 11, v69
    v_lshl_or_b32 v33, v69, 23, v33
    v_lshl_or_b32 v34, v70, 3, v34
    v_lshrrev_b32 v70, 11, v70
    v_lshl_or_b32 v34, v70, 23, v34
    v_lshl_or_b32 v35, v71, 3, v35
    v_lshrrev_b32 v71, 11, v71
    v_lshl_or_b32 v35, v71, 23, v35
    s_waitcnt vmcnt(2)
    s_mov_b64 exec, s[56:57]
    s_waitcnt lgkmcnt(3)
    v_add_u32 v36, v28, v36
    v_add_u32 v28, v36, v36
    ds_write_b32 v36, v32 offset:0
    ds_write_b64 v28, v[72:73] offset:13568
    s_mov_b64 exec, s[58:59]
    s_waitcnt lgkmcnt(4)
    v_add_u32 v37, v29, v37
    v_add_u32 v29, v37, v37
    ds_write_b32 v37, v33 offset:0
    ds_write_b64 v29, v[74:75] offset:13568
    s_mov_b64 exec, s[60:61]
    s_waitcnt lgkmcnt(5)
    v_add_u32 v38, v30, v38
    v_add_u32 v30, v38, v38
    ds_write_b32 v38, v34 offset:0
    ds_write_b64 v30, v[76:77] offset:13568
    s_mov_b64 exec, s[62:63]
    s_cbranch_execz L_B2
    s_waitcnt lgkmcnt(6)
    v_add_u32 v39, v31, v39
    v_add_u32 v31, v39, v39
    ds_write_b32 v39, v35 offset:0
    ds_write_b64 v31, v[78:79] offset:13568
L_B2:
    s_mov_b64 exec, -1
    v_mov_b32 v13, 56328
    ds_read_b32 v13, v13
    v_add_u32 v28, 16384, v26
    v_lshlrev_b32 v12, 3, v1
    s_waitcnt lgkmcnt(0)
    v_readfirstlane_b32 s84, v13
    s_barrier
    s_add_u32 s84, s84, 127
    s_and_b32 s34, s84, -128
    s_lshl_b32 s38, s34, 1
    ds_read_b128 v[64:67], v26 offset:0
    ds_read_b128 v[68:71], v26 offset:13568
    ds_read_b128 v[72:75], v26 offset:29952
    ds_read_b64 v[92:93], v12 offset:57344
    ds_read_b64 v[94:95], v12 offset:57856
    s_waitcnt lgkmcnt(4)
    buffer_store_dwordx4 v[64:67], v26, s[32:35], 0 offen sc1
    v_mov_b32 v62, v26
    v_mov_b32 v63, v28
    s_waitcnt vmcnt(2) lgkmcnt(0)
    v_readfirstlane_b32 s100, v10
    s_mov_b32 s84, 0x40000
L_TAGP:
    s_cmp_lg_u32 s100, 0
    s_cbranch_scc1 L_TAGD
    v_mov_b32 v12, 0
    global_load_dword v10, v12, s[96:97] sc1
    s_waitcnt vmcnt(0)
    v_readfirstlane_b32 s100, v10
    s_sub_u32 s84, s84, 1
    s_cbranch_scc1 L_END
    s_branch L_TAGP
L_TAGD:
    s_mul_i32 s101, s100, 0x9e3779b1
    s_and_b32 s101, s101, 0xc003c003
    v_or_b32 v120, s101, v92
    v_mov_b32 v121, s100
    v_or_b32 v122, s101, v93
    v_mov_b32 v123, s100
    v_or_b32 v124, s101, v94
    v_mov_b32 v125, s100
    v_or_b32 v126, s101, v95
    v_mov_b32 v127, s100
    v_lshlrev_b32 v26, 4, v0
    v_mov_b32 v28, 0
    v_mov_b32 v29, 0
    v_mov_b32 v30, 0
    v_mov_b32 v31, 0
    v_add_u32 v27, 67840, v26
    ds_write_b128 v27, v[28:31] offset:0
    v_and_b32 v32, 15, v0
    v_lshlrev_b32 v32, 10, v32
    v_add_u32 v32, 67840, v32
    v_add_u32 v33, 256, v32
    v_add_u32 v34, 512, v32
    v_add_u32 v35, 768, v32
    v_add_u32 v27, 84224, v26
    v_cmp_gt_u32 vcc, 160, v0
    s_and_saveexec_b64 s[80:81], vcc
    ds_write_b128 v27, v[32:35]
    s_mov_b64 exec, s[80:81]
    v_lshlrev_b32 v60, 4, v1
    s_waitcnt vmcnt(0)
    s_barrier
    s_cmp_lg_u32 s72, 0
    s_cbranch_scc1 L_POLL0
    buffer_store_dwordx4 v[120:123], v60, s[40:43], 0 offen sc1
    buffer_store_dwordx4 v[124:127], v60, s[40:43], 0 offen offset:1024 sc1
L_POLL0:
    buffer_store_dwordx4 v[68:71], v62, s[36:39], 0 offen sc1
    buffer_store_dwordx4 v[72:75], v63, s[36:39], 0 offen sc1
    ds_read_b64_tr_b16 v[96:97], v7 offset:0
    ds_read_b64_tr_b16 v[98:99], v7 offset:512
    ds_read_b64_tr_b16 v[100:101], v7 offset:4096
    ds_read_b64_tr_b16 v[102:103], v7 offset:4608
    ds_read_b64_tr_b16 v[104:105], v7 offset:25600
    ds_read_b64_tr_b16 v[106:107], v7 offset:26112
    ds_read_b64_tr_b16 v[108:109], v7 offset:29696
    ds_read_b64_tr_b16 v[110:111], v7 offset:30208
    s_mov_b32 s88, 0xbfb8aa3b
    s_mov_b32 s89, 0x5e000000
    v_mov_b32 v13, 0xc1f80000
    s_and_b32 s90, s72, 3
    s_waitcnt lgkmcnt(4)
    v_mfma_f32_16x16x32_bf16 v[112:115], v[80:83], v[96:99], 0
    v_mfma_f32_16x16x32_bf16 v[112:115], v[84:87], v[100:103], v[112:115]
    s_waitcnt lgkmcnt(0)
    v_mfma_f32_16x16x32_bf16 v[116:119], v[80:83], v[104:107], 0
    v_mfma_f32_16x16x32_bf16 v[116:119], v[84:87], v[108:111], v[116:119]
    s_nop 4
    v_fma_f32 v112, v112, s88, v13
    v_fma_f32 v113, v113, s88, v13
    v_fma_f32 v114, v114, s88, v13
    v_fma_f32 v115, v115, s88, v13
    v_cvt_pk_bf16_f32 v12, v112, v113
    v_lshlrev_b32 v13, 16, v12
    v_and_b32 v12, 0xffff0000, v12
    v_sub_f32 v112, v112, v13
    v_sub_f32 v113, v113, v12
    v_cvt_pk_bf16_f32 v112, v13, v112
    v_cvt_pk_bf16_f32 v113, v12, v113
    v_cvt_pk_bf16_f32 v12, v114, v115
    v_lshlrev_b32 v13, 16, v12
    v_and_b32 v12, 0xffff0000, v12
    v_sub_f32 v114, v114, v13
    v_sub_f32 v115, v115, v12
    v_cvt_pk_bf16_f32 v114, v13, v114
    v_cvt_pk_bf16_f32 v115, v12, v115
    v_mul_f32 v116, s89, v116
    v_mul_f32 v117, s89, v117
    v_mul_f32 v118, s89, v118
    v_mul_f32 v119, s89, v119
    s_cmp_eq_u32 s90, 3
    s_cselect_b64 exec, 0xffff, -1
    ds_write_b32 v9, v112
    ds_write_b32 v9, v116 offset:12544
    s_cselect_b64 exec, 0, -1
    ds_write_b32 v9, v113 offset:256
    ds_write_b32 v9, v117 offset:12800
    ds_write_b32 v9, v114 offset:512
    ds_write_b32 v9, v118 offset:13056
    ds_write_b32 v9, v115 offset:768
    ds_write_b32 v9, v119 offset:13312
    s_mov_b64 exec, -1
    v_bfe_u32 v13, v1, 2, 2
    v_lshlrev_b32 v13, 7, v13
    v_bfe_u32 v15, v1, 4, 1
    v_lshl_add_u32 v13, v15, 5, v13
    v_and_b32 v15, 3, v1
    v_lshl_add_u32 v13, v15, 3, v13
    v_and_b32 v15, 8, v1
    v_lshlrev_b32 v15, 2, v15
    v_xor_b32 v13, v13, v15
    v_add_u32 v13, 128256, v13
    ds_read_b64_tr_b16 v[96:97], v13
    ds_read_b64_tr_b16 v[98:99], v13 offset:64
    s_mov_b32 s88, 0xbfb8aa3b
    v_cmp_lt_u32 vcc, 31, v1
    s_waitcnt lgkmcnt(0)
    v_lshlrev_b32 v100, 16, v96
    v_and_b32 v101, 0xffff0000, v96
    v_lshlrev_b32 v102, 16, v97
    v_and_b32 v103, 0xffff0000, v97
    v_lshlrev_b32 v104, 16, v98
    v_and_b32 v105, 0xffff0000, v98
    v_lshlrev_b32 v106, 16, v99
    v_and_b32 v107, 0xffff0000, v99
    v_mul_f32 v100, s88, v100
    v_mul_f32 v101, s88, v101
    v_mul_f32 v102, s88, v102
    v_mul_f32 v103, s88, v103
    v_mul_f32 v104, s88, v104
    v_mul_f32 v105, s88, v105
    v_mul_f32 v106, s88, v106
    v_mul_f32 v107, s88, v107
    v_cvt_pk_bf16_f32 v96, v100, v101
    v_lshlrev_b32 v12, 16, v96
    v_and_b32 v13, 0xffff0000, v96
    v_sub_f32 v12, v100, v12
    v_sub_f32 v13, v101, v13
    v_cvt_pk_bf16_f32 v12, v12, v13
    v_cndmask_b32 v48, v96, v12, vcc
    v_cvt_pk_bf16_f32 v97, v102, v103
    v_lshlrev_b32 v12, 16, v97
    v_and_b32 v13, 0xffff0000, v97
    v_sub_f32 v12, v102, v12
    v_sub_f32 v13, v103, v13
    v_cvt_pk_bf16_f32 v12, v12, v13
    v_cndmask_b32 v49, v97, v12, vcc
    v_cvt_pk_bf16_f32 v98, v104, v105
    v_lshlrev_b32 v12, 16, v98
    v_and_b32 v13, 0xffff0000, v98
    v_sub_f32 v12, v104, v12
    v_sub_f32 v13, v105, v13
    v_cvt_pk_bf16_f32 v12, v12, v13
    v_cndmask_b32 v52, v98, v12, vcc
    v_cvt_pk_bf16_f32 v99, v106, v107
    v_lshlrev_b32 v12, 16, v99
    v_and_b32 v13, 0xffff0000, v99
    v_sub_f32 v12, v106, v12
    v_sub_f32 v13, v107, v13
    v_cvt_pk_bf16_f32 v12, v12, v13
    v_cndmask_b32 v53, v99, v12, vcc
    s_lshl_b32 s85, s3, 3
    v_add_u32 v76, s85, v22
    v_add_u32 v77, 131072, v76
    v_lshrrev_b32 v22, 4, v22
    v_add_u32 v22, 0x80000, v22
    v_add_u32 v23, 8192, v22
    s_mul_i32 s11, s100, 0x85ebca6b
    s_lshl_b32 s84, s2, 7
    s_add_u32 s84, s84, 0x80000
    v_mov_b32 v60, s84
    v_mov_b32 v62, s100
    v_mov_b32 v63, s11
    s_mov_b64 s[56:57], -1
    s_mov_b64 s[58:59], -1
    s_waitcnt vmcnt(0)
    s_barrier
    s_cmp_lg_u32 s72, 0
    s_cbranch_scc1 L_FLAG2
    s_mov_b64 exec, 1
    buffer_store_dwordx2 v[62:63], v60, s[28:31], 0 offen sc1
    s_mov_b64 exec, -1
L_FLAG2:
    buffer_load_dwordx2 v[64:65], v76, s[28:31], 0 offen sc1
    buffer_load_dwordx2 v[66:67], v77, s[28:31], 0 offen sc1
    v_lshlrev_b32 v26, 4, v0
    v_and_b32 v28, 7, v0
    v_lshlrev_b32 v28, 5, v28
    v_add_u32 v28, 100000, v28
    v_add_u32 v29, 8, v28
    v_add_u32 v30, 16, v28
    v_add_u32 v31, 24, v28
    ds_write_b128 v26, v[28:31] offset:0
    v_cmp_gt_u32 vcc, 144, v0
    s_and_saveexec_b64 s[80:81], vcc
    ds_write_b128 v26, v[28:31] offset:16384
    s_mov_b64 exec, s[80:81]
    v_lshlrev_b32 v26, 4, v0
    v_mov_b32 v28, 0
    v_mov_b32 v29, 0
    v_mov_b32 v30, 0
    v_mov_b32 v31, 0
    ds_write_b128 v26, v[28:31] offset:18688
    ds_write_b128 v26, v[28:31] offset:35072
    v_cmp_gt_u32 vcc, 288, v0
    s_and_saveexec_b64 s[80:81], vcc
    ds_write_b128 v26, v[28:31] offset:51456
    s_mov_b64 exec, s[80:81]
    v_lshrrev_b32 v13, 5, v1
    s_lshl_b32 s84, s72, 4
    s_add_u32 s84, s84, 59392
    v_lshlrev_b32 v15, 3, v13
    v_add_u32 v13, v13, v13
    v_add_u32 v15, s84, v15
    v_bfe_u32 v10, v1, 2, 1
    v_and_b32 v14, 1, v1
    v_lshl_or_b32 v10, v10, 1, v14
    v_bfe_u32 v14, v1, 3, 2
    v_bfe_u32 v12, v1, 1, 1
    v_lshl_or_b32 v14, v14, 1, v12
    v_lshlrev_b32 v14, 3, v14
    v_add_u32 v14, 18688, v14
    s_mov_b32 s84, 0x40000
    s_mov_b32 s85, 0xc003c003
    s_branch L_POLLC
L_POLL:
    s_mov_b64 exec, s[56:57]
    buffer_load_dwordx2 v[64:65], v76, s[28:31], 0 offen sc1
    s_mov_b64 exec, s[58:59]
    buffer_load_dwordx2 v[66:67], v77, s[28:31], 0 offen sc1
L_POLLC:
    s_waitcnt vmcnt(1)
    s_mov_b64 exec, s[56:57]
    v_xor_b32 v20, s101, v64
    v_xor_b32 v65, s100, v65
    v_and_or_b32 v65, v20, s85, v65
    v_cmp_ne_u32 s[56:57], 0, v65
    s_waitcnt vmcnt(0)
    s_mov_b64 exec, s[58:59]
    v_xor_b32 v21, s101, v66
    v_xor_b32 v67, s100, v67
    v_and_or_b32 v67, v21, s85, v67
    v_cmp_ne_u32 s[58:59], 0, v67
    s_or_b64 s[86:87], s[56:57], s[58:59]
    s_cbranch_scc0 L_POLLED
    s_sub_u32 s84, s84, 1
    s_cbranch_scc1 L_END
    s_branch L_POLL
L_POLLED:
    s_mov_b64 exec, -1
L_PASS:
    v_add_u32 v36, s75, v25
    v_add_u32 v34, s75, v24
    v_add_u32_sdwa v26, v20, v36 dst_sel:DWORD dst_unused:UNUSED_PAD src0_sel:WORD_0 src1_sel:DWORD
    v_cmp_lt_u32_sdwa s[56:57], v34, v20 src0_sel:DWORD src1_sel:WORD_1
    v_add_u32 v96, v26, v26
    s_mov_b64 exec, s[56:57]
    buffer_load_dwordx2 v[68:69], v26, s[20:23], 0 offen sc1
    s_mov_b64 exec, -1
    v_add_u32_sdwa v27, v21, v36 dst_sel:DWORD dst_unused:UNUSED_PAD src0_sel:WORD_0 src1_sel:DWORD
    v_cmp_lt_u32_sdwa s[60:61], v34, v21 src0_sel:DWORD src1_sel:WORD_1
    v_add_u32 v27, 868352, v27
    v_add_u32 v97, v27, v27
    s_mov_b64 exec, s[60:61]
    buffer_load_dwordx2 v[76:77], v27, s[20:23], 0 offen sc1
    s_mov_b64 exec, -1
    v_add_u32 v35, s76, v34
    v_add_u32 v36, 4, v34
    s_cmp_eq_u32 s76, 128
    s_cselect_b32 s84, 64, 0x10000
    v_add_u32 v34, s84, v34
    v_cmp_lt_u32_sdwa s[64:65], v34, v20 src0_sel:DWORD src1_sel:WORD_1
    v_cmp_lt_u32_sdwa s[58:59], v36, v20 src0_sel:DWORD src1_sel:WORD_1
    v_cmp_lt_u32_sdwa s[68:69], v34, v21 src0_sel:DWORD src1_sel:WORD_1
    v_cmp_lt_u32_sdwa s[62:63], v36, v21 src0_sel:DWORD src1_sel:WORD_1
    v_add_u32 v34, 4, v34
    s_mov_b64 exec, s[64:65]
    buffer_load_dwordx2 v[84:85], v26, s[20:23], 0 offen offset:64 sc1
    s_mov_b64 exec, s[68:69]
    buffer_load_dwordx2 v[92:93], v27, s[20:23], 0 offen offset:64 sc1
    s_mov_b64 exec, -1
    v_cmp_lt_u32_sdwa s[66:67], v34, v20 src0_sel:DWORD src1_sel:WORD_1
    v_cmp_lt_u32_sdwa s[70:71], v34, v21 src0_sel:DWORD src1_sel:WORD_1
    v_cmp_lt_u32_sdwa vcc, v35, v20 src0_sel:DWORD src1_sel:WORD_1
    v_cmp_lt_u32_sdwa s[84:85], v35, v21 src0_sel:DWORD src1_sel:WORD_1
    v_mov_b32 v34, 4
    s_or_b64 vcc, vcc, s[84:85]
    s_cbranch_scc0 L_NOMORE
    v_mov_b32 v35, 56320
    ds_write_b32 v35, v34
L_NOMORE:
    s_waitcnt vmcnt(3)
    s_mov_b64 exec, s[56:57]
    v_lshrrev_b32 v26, 21, v68
    ds_add_rtn_u32 v70, v26, v34 offset:61952
    v_and_b32 v68, 0x1fff8, v68
    s_mov_b64 exec, s[58:59]
    v_lshrrev_b32 v27, 21, v69
    ds_add_rtn_u32 v71, v27, v34 offset:61952
    v_and_b32 v69, 0x1fff8, v69
    s_waitcnt vmcnt(2)
    s_mov_b64 exec, s[60:61]
    v_lshrrev_b32 v28, 21, v76
    ds_add_rtn_u32 v78, v28, v34 offset:61952
    v_and_b32 v76, 0x1fff8, v76
    s_mov_b64 exec, s[62:63]
    v_lshrrev_b32 v29, 21, v77
    ds_add_rtn_u32 v79, v29, v34 offset:61952
    v_and_b32 v77, 0x1fff8, v77
    s_mov_b64 exec, s[64:65]
    s_cbranch_execz L_C4
    s_waitcnt vmcnt(1)
    v_lshrrev_b32 v30, 21, v84
    ds_add_rtn_u32 v86, v30, v34 offset:61952
    v_and_b32 v84, 0x1fff8, v84
L_C4:
    s_mov_b64 exec, s[66:67]
    s_cbranch_execz L_C5
    v_lshrrev_b32 v31, 21, v85
    ds_add_rtn_u32 v87, v31, v34 offset:61952
    v_and_b32 v85, 0x1fff8, v85
L_C5:
    s_mov_b64 exec, s[68:69]
    s_cbranch_execz L_C6
    s_waitcnt vmcnt(0)
    v_lshrrev_b32 v32, 21, v92
    ds_add_rtn_u32 v94, v32, v34 offset:61952
    v_and_b32 v92, 0x1fff8, v92
L_C6:
    s_mov_b64 exec, s[70:71]
    s_cbranch_execz L_C7
    v_lshrrev_b32 v33, 21, v93
    ds_add_rtn_u32 v95, v33, v34 offset:61952
    v_and_b32 v93, 0x1fff8, v93
L_C7:
    s_mov_b64 exec, -1
    buffer_load_dwordx2 v[100:101], v22, s[28:31], 0 offen sc1
    buffer_load_dwordx2 v[102:103], v23, s[28:31], 0 offen sc1
L_EDONE:
    v_lshlrev_b32 v34, 2, v1
    v_mov_b32 v35, 56320
    s_waitcnt lgkmcnt(0)
    s_barrier
    s_cmp_lg_u32 s72, 15
    s_cbranch_scc1 L_TP
    s_setprio 2
L_TP:
    v_lshlrev_b32 v98, 5, v1
    ds_read_b128 v[104:107], v98 offset:61952
    ds_read_b128 v[108:111], v98 offset:61968
    ds_read_b32 v35, v35
    s_waitcnt lgkmcnt(1)
    v_add3_u32 v36, v104, v105, v106
    v_add3_u32 v37, v107, v108, v109
    v_add3_u32 v36, v36, v110, v111
    v_add3_u32 v36, v36, v37, 28
    v_and_b32 v36, 0xffffffe0, v36
    v_mov_b32 v37, v36
    s_nop 1
    v_add_u32_dpp v37, v37, v37 row_shr:1 row_mask:0xf bank_mask:0xf
    s_nop 1
    v_add_u32_dpp v37, v37, v37 row_shr:2 row_mask:0xf bank_mask:0xf
    s_nop 1
    v_add_u32_dpp v37, v37, v37 row_shr:4 row_mask:0xf bank_mask:0xf
    s_nop 1
    v_add_u32_dpp v37, v37, v37 row_shr:8 row_mask:0xf bank_mask:0xf
    s_nop 1
    v_add_u32_dpp v37, v37, v37 row_bcast:15 row_mask:0xa bank_mask:0xf
    s_nop 1
    v_add_u32_dpp v37, v37, v37 row_bcast:31 row_mask:0xc bank_mask:0xf
    s_nop 1
    v_readlane_b32 s84, v37, 63
    v_sub_u32 v37, v37, v36
    s_waitcnt lgkmcnt(0)
    v_readfirstlane_b32 s77, v35
    s_lshr_b32 s84, s84, 5
    s_cmp_eq_u32 s76, 128
    s_cselect_b32 s85, 576, -1
    s_cmp_gt_u32 s84, s85
    s_cbranch_scc1 L_OVERFLOW
    s_add_u32 s84, s84, 3
    s_lshr_b32 s84, s84, 2
    s_lshr_b32 s88, s84, 4
    s_and_b32 s89, s84, 15
    s_add_u32 s85, s88, 1
    v_cvt_f32_u32 v38, s85
    v_cvt_f32_u32 v39, s88
    v_rcp_f32 v38, v38
    v_rcp_f32 v39, v39
    s_mul_i32 s90, s89, s85
    s_lshl_b32 s90, s90, 2
    v_lshrrev_b32 v37, 5, v37
    v_mul_f32 v38, 0x47800000, v38
    v_mul_f32 v39, 0x47800000, v39
    v_lshrrev_b32 v36, 5, v36
    v_cvt_u32_f32 v38, v38
    v_cvt_u32_f32 v39, v39
    s_cmp_lt_u32 s72, s89
    s_cselect_b32 s73, s85, s88
    v_add_u32 v38, 2, v38
    v_add_u32 v39, 2, v39
    s_min_u32 s84, s72, s89
    s_mul_i32 s87, s72, s88
    s_add_u32 s87, s87, s84
    s_sub_u32 s85, 0, s85
    s_sub_u32 s88, 0, s88
    s_lshl_b32 s89, s89, 2
    s_cmp_lg_u32 s72, 15
    s_cbranch_scc1 L_NOTAB
    v_subrev_u32 v61, s90, v37
    v_cmp_gt_u32 vcc, s90, v37
    v_mul_u32_u24 v62, v37, v38
    v_mul_u32_u24 v63, v61, v39
    v_lshrrev_b32 v62, 16, v62
    v_lshrrev_b32 v63, 16, v63
    v_mad_i32_i24 v60, v62, s85, v37
    v_mad_i32_i24 v61, v63, s88, v61
    v_mov_b32 v62, s85
    v_mov_b32 v63, s88
    v_cndmask_b32 v60, v61, v60, vcc
    v_cndmask_b32 v62, v63, v62, vcc
    v_add_u32 v105, v105, v104
    v_add_u32 v62, v62, v60
    v_add_u32 v106, v106, v105
    v_sub_u32 v62, 0, v62
    v_add_u32 v107, v107, v106
    v_cmp_ne_u32 vcc, 0, v60
    v_add_u32 v108, v108, v107
    v_cmp_lt_u32 s[80:81], v62, v36
    v_add_u32 v109, v109, v108
    s_and_b64 vcc, vcc, s[80:81]
    v_add_u32 v110, v110, v109
    v_lshlrev_b32 v62, 5, v62
    v_add_u32 v111, v111, v110
    v_cndmask_b32 v62, 0, v62, vcc
    v_add_u32 v61, 20, v111
    v_sub_u32 v61, v61, v62 clamp
    v_sub_u32 v112, v61, v104
    v_sub_u32 v113, v61, v105
    v_sub_u32 v114, v61, v106
    v_sub_u32 v115, v61, v107
    v_sub_u32 v116, v61, v108
    v_sub_u32 v117, v61, v109
    v_sub_u32 v118, v61, v110
    v_sub_u32 v119, v61, v111
    v_min3_u32 v112, v112, v113, v114
    v_min3_u32 v115, v115, v116, v117
    v_min3_u32 v112, v112, v118, v119
    v_min3_u32 v112, v112, v115, v61
    v_sub_u32 v61, v61, v112
    v_lshlrev_b32 v63, 5, v37
    v_sub_u32 v112, 0, v61
    v_sub_u32 v113, v104, v61
    v_sub_u32 v114, v105, v61
    v_sub_u32 v115, v106, v61
    v_sub_u32 v116, v107, v61
    v_sub_u32 v117, v108, v61
    v_sub_u32 v118, v109, v61
    v_sub_u32 v119, v110, v61
    v_add_u32 v120, v112, v111
    v_add_u32 v121, v113, v111
    v_add_u32 v122, v114, v111
    v_add_u32 v123, v115, v111
    v_add_u32 v124, v116, v111
    v_add_u32 v125, v117, v111
    v_add_u32 v126, v118, v111
    v_add_u32 v127, v119, v111
    v_min_u32 v112, v112, v120
    v_min_u32 v113, v113, v121
    v_min_u32 v114, v114, v122
    v_min_u32 v115, v115, v123
    v_min_u32 v116, v116, v124
    v_min_u32 v117, v117, v125
    v_min_u32 v118, v118, v126
    v_min_u32 v119, v119, v127
    v_add_u32 v112, v112, v63
    v_add_u32 v113, v113, v63
    v_add_u32 v114, v114, v63
    v_add_u32 v115, v115, v63
    v_add_u32 v116, v116, v63
    v_add_u32 v117, v117, v63
    v_add_u32 v118, v118, v63
    v_add_u32 v119, v119, v63
    v_lshlrev_b32 v60, 5, v1
    s_mov_b32 exec_hi, 0x1ffff
    ds_write_b128 v60, v[112:115] offset:64000
    ds_write_b128 v60, v[116:119] offset:64016
    v_mov_b32 v61, 56336
    ds_write_b32 v61, v61
    s_mov_b64 exec, -1
    s_setprio 0
L_NOTAB:
    v_lshlrev_b32 v98, 8, v1
    v_add_u32 v99, 99328, v98
    s_mov_b32 s84, s72
L_DLOOP:
    v_cmp_lt_u32 vcc, s84, v36
    s_and_b64 exec, exec, vcc
    s_cbranch_execz L_DEND
    v_add_u32 v60, s84, v37
    v_subrev_u32 v61, s90, v60
    v_cmp_gt_u32 vcc, s90, v60
    v_mul_u32_u24 v62, v60, v38
    v_mul_u32_u24 v63, v61, v39
    v_lshrrev_b32 v62, 16, v62
    v_lshrrev_b32 v63, 16, v63
    v_mad_i32_i24 v60, v62, s85, v60
    v_mad_i32_i24 v61, v63, s88, v61
    v_add_u32 v63, s89, v63
    v_cndmask_b32 v60, v61, v60, vcc
    v_cndmask_b32 v62, v63, v62, vcc
    v_cmp_le_u32 vcc, s84, v60
    v_lshl_add_u32 v60, v60, 6, v62
    v_lshlrev_b32 v61, 8, v62
    v_lshlrev_b32 v60, 2, v60
    v_add_u32 v61, 67840, v61
    v_add_u32 v63, 84224, v60
    v_cndmask_b32 v61, v61, v99, vcc
    ds_write_b32 v60, v98 offset:59392
    ds_write_b32 v63, v61
    s_add_u32 s91, s84, 1
    v_cmp_eq_u32 vcc, s91, v36
    s_and_saveexec_b64 s[80:81], vcc
    ds_write_b32 v34, v62 offset:57088
    s_mov_b64 exec, s[80:81]
    s_cmp_lg_u32 s84, 0
    s_cbranch_scc1 L_DNF
    ds_write_b32 v34, v62 offset:56832
L_DNF:
    s_add_u32 s84, s84, 16
    s_branch L_DLOOP
L_DEND:
    s_mov_b64 exec, -1
    s_lshl_b32 s84, s87, 7
    s_lshl_b32 s85, s73, 5
    v_mov_b32 v60, s84
    v_mad_u32_u24 v12, v13, s85, v60
    v_add_u32 v60, v60, v60
    v_add_u32 v13, s85, v12
    v_add_u32 v14, v14, v60
    s_lshl_b32 s85, s73, 6
    v_mad_u32_u24 v14, v10, s85, v14
    s_mov_b32 s74, s73
    s_mov_b32 s87, 0x40000
L_POLL2:
    s_waitcnt vmcnt(0)
    v_xor_b32 v100, s100, v100
    v_xor_b32 v101, s11, v101
    v_xor_b32 v102, s100, v102
    v_xor_b32 v103, s11, v103
    v_or3_b32 v100, v100, v101, v102
    v_or_b32 v100, v100, v103
    v_cmp_ne_u32 vcc, 0, v100
    s_sub_u32 s87, s87, 1
    s_cbranch_scc1 L_END
    s_cbranch_vccz L_POLLED2
    buffer_load_dwordx2 v[100:101], v22, s[28:31], 0 offen sc1
    buffer_load_dwordx2 v[102:103], v23, s[28:31], 0 offen sc1
    s_branch L_POLL2
L_POLLED2:
    s_mov_b64 exec, s[56:57]
    buffer_load_dwordx4 v[64:67], v96, s[24:27], 0 offen offset:0 sc1
    s_mov_b64 exec, s[60:61]
    buffer_load_dwordx4 v[72:75], v97, s[24:27], 0 offen offset:0 sc1
    s_mov_b64 exec, s[64:65]
    buffer_load_dwordx4 v[80:83], v96, s[24:27], 0 offen offset:128 sc1
    s_mov_b64 exec, s[68:69]
    buffer_load_dwordx4 v[88:91], v97, s[24:27], 0 offen offset:128 sc1
    s_mov_b64 exec, -1
L_HAVEE:
    v_mov_b32 v60, 56336
    s_mov_b32 s85, 0x1000000
L_TWAIT:
    s_sub_u32 s85, s85, 1
    s_cbranch_scc1 L_END
    ds_read_b32 v61, v60
    s_waitcnt lgkmcnt(0)
    v_readfirstlane_b32 s84, v61
    s_cmp_eq_u32 s84, 0
    s_cbranch_scc1 L_TWAIT
    s_mov_b64 exec, s[56:57]
    ds_read_b32 v26, v26 offset:64000
    s_mov_b64 exec, s[58:59]
    ds_read_b32 v27, v27 offset:64000
    s_mov_b64 exec, s[60:61]
    ds_read_b32 v28, v28 offset:64000
    s_mov_b64 exec, s[62:63]
    ds_read_b32 v29, v29 offset:64000
    s_mov_b64 exec, s[64:65]
    ds_read_b32 v30, v30 offset:64000
    s_mov_b64 exec, s[66:67]
    ds_read_b32 v31, v31 offset:64000
    s_mov_b64 exec, s[68:69]
    ds_read_b32 v32, v32 offset:64000
    s_mov_b64 exec, s[70:71]
    ds_read_b32 v33, v33 offset:64000
    s_mov_b64 exec, s[56:57]
    s_waitcnt lgkmcnt(7)
    v_add_u32 v26, v26, v70
    v_add_u32 v70, v26, v26
    ds_write_b32 v26, v68 offset:0
    s_mov_b64 exec, s[58:59]
    s_waitcnt lgkmcnt(7)
    v_add_u32 v27, v27, v71
    v_add_u32 v71, v27, v27
    ds_write_b32 v27, v69 offset:0
    s_mov_b64 exec, s[60:61]
    s_waitcnt lgkmcnt(7)
    v_add_u32 v28, v28, v78
    v_add_u32 v78, v28, v28
    ds_write_b32 v28, v76 offset:0
    s_mov_b64 exec, s[62:63]
    s_waitcnt lgkmcnt(7)
    v_add_u32 v29, v29, v79
    v_add_u32 v79, v29, v29
    ds_write_b32 v29, v77 offset:0
    s_mov_b64 exec, s[64:65]
    s_cbranch_execz L_Pb4
    s_waitcnt lgkmcnt(7)
    v_add_u32 v30, v30, v86
    v_add_u32 v86, v30, v30
    ds_write_b32 v30, v84 offset:0
L_Pb4:
    s_mov_b64 exec, s[66:67]
    s_cbranch_execz L_Pb5
    s_waitcnt lgkmcnt(6)
    v_add_u32 v31, v31, v87
    v_add_u32 v87, v31, v31
    ds_write_b32 v31, v85 offset:0
L_Pb5:
    s_mov_b64 exec, s[68:69]
    s_cbranch_execz L_Pb6
    s_waitcnt lgkmcnt(5)
    v_add_u32 v32, v32, v94
    v_add_u32 v94, v32, v32
    ds_write_b32 v32, v92 offset:0
L_Pb6:
    s_mov_b64 exec, s[70:71]
    s_cbranch_execz L_Pb7
    s_waitcnt lgkmcnt(4)
    v_add_u32 v33, v33, v95
    v_add_u32 v95, v33, v33
    ds_write_b32 v33, v93 offset:0
L_Pb7:
    s_mov_b64 exec, 1
    v_mov_b32 v60, 56344
    v_mov_b32 v61, 1
    ds_add_u32 v60, v61
    s_mov_b64 exec, -1
    s_lshr_b32 s91, s2, 3
    s_lshl_b32 s91, s91, 4
    s_add_u32 s91, s91, s72
    s_mul_i32 s91, s91, 640
    v_lshlrev_b32 v60, 7, v1
    v_add_u32 v60, s91, v60
    s_add_u32 s44, s94, 0xc00000
    s_addc_u32 s45, s95, 0
    s_mov_b32 s46, 3211264
    s_mov_b32 s47, 0x00020000
    s_mov_b64 exec, 0x1f
    buffer_load_dword v62, v60, s[44:47], 0 offen sc1
    s_mov_b64 exec, s[56:57]
    s_waitcnt vmcnt(4)
    ds_write_b64 v70, v[64:65] offset:18688
    s_mov_b64 exec, s[58:59]
    ds_write_b64 v71, v[66:67] offset:18688
    s_mov_b64 exec, s[60:61]
    s_waitcnt vmcnt(3)
    ds_write_b64 v78, v[72:73] offset:18688
    s_mov_b64 exec, s[62:63]
    ds_write_b64 v79, v[74:75] offset:18688
    s_mov_b64 exec, s[64:65]
    s_cbranch_execz L_Qb4
    s_waitcnt vmcnt(2)
    ds_write_b64 v86, v[80:81] offset:18688
L_Qb4:
    s_mov_b64 exec, s[66:67]
    s_cbranch_execz L_Qb5
    ds_write_b64 v87, v[82:83] offset:18688
L_Qb5:
    s_mov_b64 exec, s[68:69]
    s_cbranch_execz L_Qb6
    s_waitcnt vmcnt(1)
    ds_write_b64 v94, v[88:89] offset:18688
L_Qb6:
    s_mov_b64 exec, s[70:71]
    s_cbranch_execz L_Qb7
    ds_write_b64 v95, v[90:91] offset:18688
L_Qb7:
    s_mov_b64 exec, -1
L_PDONE:
    s_cmp_ge_u32 s72, 8
    s_cbranch_scc1 L_NOEARLY
    s_cmp_eq_u32 s73, 0
    s_cbranch_scc1 L_NOEARLY
    v_mov_b32 v61, 56344
    s_mov_b32 s85, 0x1000000
L_WWAIT:
    s_sub_u32 s85, s85, 1
    s_cbranch_scc1 L_END
    ds_read_b32 v63, v61
    s_waitcnt lgkmcnt(0)
    v_readfirstlane_b32 s84, v63
    s_cmp_lt_u32 s84, 16
    s_cbranch_scc1 L_WWAIT
    ds_read_b128 v[112:115], v12 offset:0
    ds_read_b128 v[116:119], v12 offset:16
    ds_read_b128 v[120:123], v13 offset:0
    ds_read_b128 v[124:127], v13 offset:16
    s_waitcnt lgkmcnt(0)
    buffer_load_dword v64, v112, s[48:51], 0 offen offset:0 sc1
    buffer_load_dword v65, v120, s[48:51], 0 offen offset:0 sc1
    buffer_load_dword v66, v113, s[48:51], 0 offen offset:0 sc1
    buffer_load_dword v67, v121, s[48:51], 0 offen offset:0 sc1
    buffer_load_dword v68, v114, s[48:51], 0 offen offset:0 sc1
    buffer_load_dword v69, v122, s[48:51], 0 offen offset:0 sc1
    buffer_load_dword v70, v115, s[48:51], 0 offen offset:0 sc1
    buffer_load_dword v71, v123, s[48:51], 0 offen offset:0 sc1
    buffer_load_dword v72, v116, s[48:51], 0 offen offset:0 sc1
    buffer_load_dword v73, v124, s[48:51], 0 offen offset:0 sc1
    buffer_load_dword v74, v117, s[48:51], 0 offen offset:0 sc1
    buffer_load_dword v75, v125, s[48:51], 0 offen offset:0 sc1
    buffer_load_dword v76, v118, s[48:51], 0 offen offset:0 sc1
    buffer_load_dword v77, v126, s[48:51], 0 offen offset:0 sc1
    buffer_load_dword v78, v119, s[48:51], 0 offen offset:0 sc1
    buffer_load_dword v79, v127, s[48:51], 0 offen offset:0 sc1
L_NOEARLY:
    s_waitcnt lgkmcnt(0)
    s_barrier
    s_cmp_eq_u32 s73, 0
    s_cbranch_scc1 L_FOLD
    s_cmp_lt_u32 s72, 8
    s_cbranch_scc1 L_HAVEG
    ds_read_b128 v[112:115], v12 offset:0
    ds_read_b128 v[116:119], v12 offset:16
    ds_read_b128 v[120:123], v13 offset:0
    ds_read_b128 v[124:127], v13 offset:16
    s_waitcnt lgkmcnt(0)
    buffer_load_dword v64, v112, s[48:51], 0 offen offset:0 sc1
    buffer_load_dword v65, v120, s[48:51], 0 offen offset:0 sc1
    buffer_load_dword v66, v113, s[48:51], 0 offen offset:0 sc1
    buffer_load_dword v67, v121, s[48:51], 0 offen offset:0 sc1
    buffer_load_dword v68, v114, s[48:51], 0 offen offset:0 sc1
    buffer_load_dword v69, v122, s[48:51], 0 offen offset:0 sc1
    buffer_load_dword v70, v115, s[48:51], 0 offen offset:0 sc1
    buffer_load_dword v71, v123, s[48:51], 0 offen offset:0 sc1
    buffer_load_dword v72, v116, s[48:51], 0 offen offset:0 sc1
    buffer_load_dword v73, v124, s[48:51], 0 offen offset:0 sc1
    buffer_load_dword v74, v117, s[48:51], 0 offen offset:0 sc1
    buffer_load_dword v75, v125, s[48:51], 0 offen offset:0 sc1
    buffer_load_dword v76, v118, s[48:51], 0 offen offset:0 sc1
    buffer_load_dword v77, v126, s[48:51], 0 offen offset:0 sc1
    buffer_load_dword v78, v119, s[48:51], 0 offen offset:0 sc1
    buffer_load_dword v79, v127, s[48:51], 0 offen offset:0 sc1
L_HAVEG:
    buffer_load_dword v80, v112, s[48:51], 0 offen offset:4 sc1
    buffer_load_dword v81, v120, s[48:51], 0 offen offset:4 sc1
    buffer_load_dword v82, v113, s[48:51], 0 offen offset:4 sc1
    buffer_load_dword v83, v121, s[48:51], 0 offen offset:4 sc1
    buffer_load_dword v84, v114, s[48:51], 0 offen offset:4 sc1
    buffer_load_dword v85, v122, s[48:51], 0 offen offset:4 sc1
    buffer_load_dword v86, v115, s[48:51], 0 offen offset:4 sc1
    buffer_load_dword v87, v123, s[48:51], 0 offen offset:4 sc1
    buffer_load_dword v88, v116, s[48:51], 0 offen offset:4 sc1
    buffer_load_dword v89, v124, s[48:51], 0 offen offset:4 sc1
    buffer_load_dword v90, v117, s[48:51], 0 offen offset:4 sc1
    buffer_load_dword v91, v125, s[48:51], 0 offen offset:4 sc1
    buffer_load_dword v92, v118, s[48:51], 0 offen offset:4 sc1
    buffer_load_dword v93, v126, s[48:51], 0 offen offset:4 sc1
    buffer_load_dword v94, v119, s[48:51], 0 offen offset:4 sc1
    buffer_load_dword v95, v127, s[48:51], 0 offen offset:4 sc1
    ds_read_b64 v[10:11], v15
    ds_read_b64 v[6:7], v15 offset:24832
    ds_read_b64 v[56:57], v14
    ds_read_b128 v[112:115], v12 offset:32
    ds_read_b128 v[116:119], v12 offset:48
    ds_read_b128 v[120:123], v13 offset:32
    ds_read_b128 v[124:127], v13 offset:48
    v_mov_b32 v26, v16
    v_mov_b32 v27, v16
    v_mov_b32 v28, v17
    v_mov_b32 v29, v17
    s_mov_b32 s88, 64
    s_mov_b32 s89, 64
    s_mov_b32 s90, 128
    s_mov_b32 s91, 512
    s_waitcnt lgkmcnt(5)
    v_lshl_add_u64 v[10:11], v[10:11], 0, v[28:29]
    v_lshl_add_u64 v[6:7], v[6:7], 0, v[26:27]
    ds_read_b32 v50, v10
    ds_read_b32 v51, v11
    ds_read_b32 v54, v10 offset:4
    ds_read_b32 v55, v11 offset:4
    s_cmp_eq_u32 s74, 1
    s_cselect_b64 s[82:83], 0, -1
    s_waitcnt lgkmcnt(0)
    s_setprio 3
    s_waitcnt vmcnt(16)
    v_mfma_f32_32x32x16_bf16 v[96:111], v[56:59], v[48:51], v[64:79]
    s_nop 3
    ds_read_b64 v[10:11], v15 offset:256
    s_nop 1
    v_lshlrev_b32 v64, 16, v64
    v_lshlrev_b32 v65, 16, v65
    v_lshlrev_b32 v66, 16, v66
    v_lshlrev_b32 v67, 16, v67
    v_lshlrev_b32 v68, 16, v68
    v_lshlrev_b32 v69, 16, v69
    v_lshlrev_b32 v70, 16, v70
    v_lshlrev_b32 v71, 16, v71
    v_exp_f32 v96, v96 clamp
    v_lshlrev_b32 v72, 16, v72
    v_exp_f32 v97, v97 clamp
    v_lshlrev_b32 v73, 16, v73
    ds_read_b32 v2, v6
    ds_read_b32 v3, v7
    ds_read_b32 v4, v6 offset:4
    ds_read_b32 v5, v7 offset:4
    ds_read_b64 v[8:9], v15 offset:25088
    v_exp_f32 v98, v98 clamp
    v_lshlrev_b32 v74, 16, v74
    v_exp_f32 v99, v99 clamp
    v_lshlrev_b32 v75, 16, v75
    v_exp_f32 v100, v100 clamp
    v_lshlrev_b32 v76, 16, v76
    v_exp_f32 v101, v101 clamp
    v_lshlrev_b32 v77, 16, v77
    v_exp_f32 v102, v102 clamp
    v_lshlrev_b32 v78, 16, v78
    v_exp_f32 v103, v103 clamp
    v_lshlrev_b32 v79, 16, v79
    v_exp_f32 v104, v104 clamp
    v_exp_f32 v105, v105 clamp
    v_exp_f32 v106, v106 clamp
    v_exp_f32 v107, v107 clamp
    s_waitcnt lgkmcnt(0)
    v_lshl_add_u64 v[10:11], v[10:11], 0, v[28:29]
    v_lshl_add_u64 v[8:9], v[8:9], 0, v[26:27]
    ds_read_b32 v50, v10
    ds_read_b32 v51, v11
    v_exp_f32 v108, v108 clamp
    v_exp_f32 v109, v109 clamp
    v_exp_f32 v110, v110 clamp
    v_exp_f32 v111, v111 clamp
    v_pk_add_f32 v[96:97], v[96:97], s[78:79]
    v_pk_add_f32 v[98:99], v[98:99], s[78:79]
    v_pk_add_f32 v[100:101], v[100:101], s[78:79]
    v_pk_add_f32 v[102:103], v[102:103], s[78:79]
    v_pk_add_f32 v[104:105], v[104:105], s[78:79]
    v_pk_add_f32 v[106:107], v[106:107], s[78:79]
    v_pk_add_f32 v[108:109], v[108:109], s[78:79]
    v_pk_add_f32 v[110:111], v[110:111], s[78:79]
    v_pk_mul_f32 v[60:61], v[64:65], v[98:99]
    v_pk_mul_f32 v[62:63], v[68:69], v[102:103]
    v_pk_mul_f32 v[98:99], v[96:97], v[98:99]
    v_pk_mul_f32 v[102:103], v[100:101], v[102:103]
    v_pk_fma_f32 v[96:97], v[66:67], v[96:97], v[60:61]
    v_pk_fma_f32 v[100:101], v[70:71], v[100:101], v[62:63]
    s_mov_b64 exec, s[82:83]
    buffer_load_dword v64, v112, s[48:51], 0 offen offset:0 sc1
    buffer_load_dword v65, v120, s[48:51], 0 offen offset:0 sc1
    buffer_load_dword v66, v113, s[48:51], 0 offen offset:0 sc1
    buffer_load_dword v67, v121, s[48:51], 0 offen offset:0 sc1
    buffer_load_dword v68, v114, s[48:51], 0 offen offset:0 sc1
    buffer_load_dword v69, v122, s[48:51], 0 offen offset:0 sc1
    buffer_load_dword v70, v115, s[48:51], 0 offen offset:0 sc1
    buffer_load_dword v71, v123, s[48:51], 0 offen offset:0 sc1
    s_mov_b64 exec, -1
    v_pk_mul_f32 v[60:61], v[72:73], v[106:107]
    v_pk_mul_f32 v[62:63], v[76:77], v[110:111]
    v_pk_mul_f32 v[106:107], v[104:105], v[106:107]
    v_pk_mul_f32 v[110:111], v[108:109], v[110:111]
    v_pk_fma_f32 v[104:105], v[74:75], v[104:105], v[60:61]
    v_pk_fma_f32 v[108:109], v[78:79], v[108:109], v[62:63]
    s_mov_b64 exec, s[82:83]
    buffer_load_dword v72, v116, s[48:51], 0 offen offset:0 sc1
    buffer_load_dword v73, v124, s[48:51], 0 offen offset:0 sc1
    buffer_load_dword v74, v117, s[48:51], 0 offen offset:0 sc1
    buffer_load_dword v75, v125, s[48:51], 0 offen offset:0 sc1
    buffer_load_dword v76, v118, s[48:51], 0 offen offset:0 sc1
    buffer_load_dword v77, v126, s[48:51], 0 offen offset:0 sc1
    buffer_load_dword v78, v119, s[48:51], 0 offen offset:0 sc1
    buffer_load_dword v79, v127, s[48:51], 0 offen offset:0 sc1
    s_mov_b64 exec, -1
    v_pk_mul_f32 v[42:43], v[96:97], v[102:103]
    v_pk_mul_f32 v[46:47], v[104:105], v[110:111]
    v_pk_mul_f32 v[40:41], v[98:99], v[102:103]
    v_pk_mul_f32 v[44:45], v[106:107], v[110:111]
    v_pk_fma_f32 v[42:43], v[100:101], v[98:99], v[42:43]
    v_pk_fma_f32 v[46:47], v[108:109], v[106:107], v[46:47]
.p2align 3
L_LOOP:
    s_cmp_eq_u32 s74, 2
    s_cbranch_scc0 L_PRm0_1
    s_setprio 1
L_PRm0_1:
    s_cmp_eq_u32 s74, 1
    s_cbranch_scc0 L_PRm0_0
    s_setprio 0
L_PRm0_0:
    s_waitcnt vmcnt(16)
    v_mfma_f32_32x32x16_bf16 v[96:111], v[56:59], v[52:55], v[80:95]
    v_rcp_f32 v40, v40
    v_rcp_f32 v41, v41
    v_rcp_f32 v44, v44
    v_rcp_f32 v45, v45
    ds_read_b64 v[56:57], v14 offset:64
    ds_read_b32 v54, v10 offset:4
    ds_read_b32 v55, v11 offset:4
    v_lshlrev_b32 v80, 16, v80
    v_lshlrev_b32 v81, 16, v81
    v_lshlrev_b32 v82, 16, v82
    v_lshlrev_b32 v83, 16, v83
    v_lshlrev_b32 v84, 16, v84
    v_lshlrev_b32 v85, 16, v85
    v_lshlrev_b32 v86, 16, v86
    v_lshlrev_b32 v87, 16, v87
    v_pk_fma_f32 v[2:3], v[42:43], v[40:41], v[2:3]
    v_exp_f32 v96, v96 clamp
    v_pk_fma_f32 v[2:3], v[46:47], v[44:45], v[2:3]
    v_lshlrev_b32 v88, 16, v88
    v_exp_f32 v97, v97 clamp
    v_lshlrev_b32 v89, 16, v89
    v_exp_f32 v98, v98 clamp
    v_lshlrev_b32 v90, 16, v90
    v_exp_f32 v99, v99 clamp
    v_lshlrev_b32 v91, 16, v91
    v_exp_f32 v100, v100 clamp
    v_lshlrev_b32 v92, 16, v92
    v_exp_f32 v101, v101 clamp
    v_lshlrev_b32 v93, 16, v93
    v_exp_f32 v102, v102 clamp
    v_lshlrev_b32 v94, 16, v94
    v_exp_f32 v103, v103 clamp
    v_lshlrev_b32 v95, 16, v95
    v_exp_f32 v104, v104 clamp
    v_exp_f32 v105, v105 clamp
    v_exp_f32 v106, v106 clamp
    v_exp_f32 v107, v107 clamp
    v_exp_f32 v108, v108 clamp
    v_exp_f32 v109, v109 clamp
    v_exp_f32 v110, v110 clamp
    v_exp_f32 v111, v111 clamp
    v_pk_add_f32 v[96:97], v[96:97], s[78:79]
    v_pk_add_f32 v[98:99], v[98:99], s[78:79]
    v_pk_add_f32 v[100:101], v[100:101], s[78:79]
    v_pk_add_f32 v[102:103], v[102:103], s[78:79]
    v_pk_add_f32 v[104:105], v[104:105], s[78:79]
    v_pk_add_f32 v[106:107], v[106:107], s[78:79]
    v_pk_add_f32 v[108:109], v[108:109], s[78:79]
    v_pk_add_f32 v[110:111], v[110:111], s[78:79]
    v_pk_mul_f32 v[60:61], v[80:81], v[98:99]
    v_pk_mul_f32 v[62:63], v[84:85], v[102:103]
    v_pk_mul_f32 v[98:99], v[96:97], v[98:99]
    v_pk_mul_f32 v[102:103], v[100:101], v[102:103]
    v_pk_fma_f32 v[96:97], v[82:83], v[96:97], v[60:61]
    v_pk_fma_f32 v[100:101], v[86:87], v[100:101], v[62:63]
    s_mov_b64 exec, s[82:83]
    buffer_load_dword v80, v112, s[48:51], 0 offen offset:4 sc1
    buffer_load_dword v81, v120, s[48:51], 0 offen offset:4 sc1
    buffer_load_dword v82, v113, s[48:51], 0 offen offset:4 sc1
    buffer_load_dword v83, v121, s[48:51], 0 offen offset:4 sc1
    buffer_load_dword v84, v114, s[48:51], 0 offen offset:4 sc1
    buffer_load_dword v85, v122, s[48:51], 0 offen offset:4 sc1
    buffer_load_dword v86, v115, s[48:51], 0 offen offset:4 sc1
    buffer_load_dword v87, v123, s[48:51], 0 offen offset:4 sc1
    s_mov_b64 exec, -1
    v_pk_mul_f32 v[60:61], v[88:89], v[106:107]
    v_pk_mul_f32 v[62:63], v[92:93], v[110:111]
    v_pk_mul_f32 v[106:107], v[104:105], v[106:107]
    v_pk_mul_f32 v[110:111], v[108:109], v[110:111]
    v_pk_fma_f32 v[104:105], v[90:91], v[104:105], v[60:61]
    v_pk_fma_f32 v[108:109], v[94:95], v[108:109], v[62:63]
    s_mov_b64 exec, s[82:83]
    buffer_load_dword v88, v116, s[48:51], 0 offen offset:4 sc1
    buffer_load_dword v89, v124, s[48:51], 0 offen offset:4 sc1
    buffer_load_dword v90, v117, s[48:51], 0 offen offset:4 sc1
    buffer_load_dword v91, v125, s[48:51], 0 offen offset:4 sc1
    buffer_load_dword v92, v118, s[48:51], 0 offen offset:4 sc1
    buffer_load_dword v93, v126, s[48:51], 0 offen offset:4 sc1
    buffer_load_dword v94, v119, s[48:51], 0 offen offset:4 sc1
    buffer_load_dword v95, v127, s[48:51], 0 offen offset:4 sc1
    s_mov_b64 exec, -1
    ds_read_b128 v[112:115], v12 offset:64
    ds_read_b128 v[116:119], v12 offset:80
    ds_read_b128 v[120:123], v13 offset:64
    ds_read_b128 v[124:127], v13 offset:80
    v_pk_mul_f32 v[42:43], v[96:97], v[102:103]
    v_pk_mul_f32 v[46:47], v[104:105], v[110:111]
    v_pk_mul_f32 v[40:41], v[98:99], v[102:103]
    v_pk_mul_f32 v[44:45], v[106:107], v[110:111]
    v_pk_fma_f32 v[42:43], v[100:101], v[98:99], v[42:43]
    v_pk_fma_f32 v[46:47], v[108:109], v[106:107], v[46:47]
    s_sub_u32 s74, s74, 1
    s_cmp_eq_u32 s74, 0
    s_cbranch_scc1 L_FIN0
    s_cmp_eq_u32 s74, 1
    s_cselect_b64 s[82:83], 0, -1
    s_cmp_eq_u32 s74, 3
    s_cbranch_scc0 L_PR0_2
    s_setprio 2
L_PR0_2:
    s_waitcnt vmcnt(16)
    s_waitcnt lgkmcnt(6)
    v_mfma_f32_32x32x16_bf16 v[96:111], v[56:59], v[48:51], v[64:79]
    v_rcp_f32 v40, v40
    v_rcp_f32 v41, v41
    v_rcp_f32 v44, v44
    v_rcp_f32 v45, v45
    ds_read_b64 v[10:11], v15 offset:512
    s_nop 1
    v_lshlrev_b32 v64, 16, v64
    v_lshlrev_b32 v65, 16, v65
    v_lshlrev_b32 v66, 16, v66
    v_lshlrev_b32 v67, 16, v67
    v_lshlrev_b32 v68, 16, v68
    v_lshlrev_b32 v69, 16, v69
    v_lshlrev_b32 v70, 16, v70
    v_lshlrev_b32 v71, 16, v71
    v_pk_fma_f32 v[4:5], v[42:43], v[40:41], v[4:5]
    v_exp_f32 v96, v96 clamp
    v_pk_fma_f32 v[4:5], v[46:47], v[44:45], v[4:5]
    v_lshlrev_b32 v72, 16, v72
    ds_write2_b32 v6, v2, v4 offset0:0 offset1:1
    ds_write2_b32 v7, v3, v5 offset0:0 offset1:1
    ds_read_b32 v2, v8
    ds_read_b32 v3, v9
    ds_read_b32 v4, v8 offset:4
    ds_read_b32 v5, v9 offset:4
    ds_read_b64 v[6:7], v15 offset:25344
    v_exp_f32 v97, v97 clamp
    v_lshlrev_b32 v73, 16, v73
    v_exp_f32 v98, v98 clamp
    v_lshlrev_b32 v74, 16, v74
    v_exp_f32 v99, v99 clamp
    v_lshlrev_b32 v75, 16, v75
    v_exp_f32 v100, v100 clamp
    v_lshlrev_b32 v76, 16, v76
    v_exp_f32 v101, v101 clamp
    v_lshlrev_b32 v77, 16, v77
    v_exp_f32 v102, v102 clamp
    v_lshlrev_b32 v78, 16, v78
    v_exp_f32 v103, v103 clamp
    v_lshlrev_b32 v79, 16, v79
    v_exp_f32 v104, v104 clamp
    v_exp_f32 v105, v105 clamp
    v_exp_f32 v106, v106 clamp
    v_exp_f32 v107, v107 clamp
    s_waitcnt lgkmcnt(0)
    v_lshl_add_u64 v[10:11], v[10:11], 0, v[28:29]
    v_lshl_add_u64 v[6:7], v[6:7], 0, v[26:27]
    ds_read_b32 v50, v10
    ds_read_b32 v51, v11
    v_exp_f32 v108, v108 clamp
    v_exp_f32 v109, v109 clamp
    v_exp_f32 v110, v110 clamp
    v_exp_f32 v111, v111 clamp
    v_pk_add_f32 v[96:97], v[96:97], s[78:79]
    v_pk_add_f32 v[98:99], v[98:99], s[78:79]
    v_pk_add_f32 v[100:101], v[100:101], s[78:79]
    v_pk_add_f32 v[102:103], v[102:103], s[78:79]
    v_pk_add_f32 v[104:105], v[104:105], s[78:79]
    v_pk_add_f32 v[106:107], v[106:107], s[78:79]
    v_pk_add_f32 v[108:109], v[108:109], s[78:79]
    v_pk_add_f32 v[110:111], v[110:111], s[78:79]
    v_pk_mul_f32 v[60:61], v[64:65], v[98:99]
    v_pk_mul_f32 v[62:63], v[68:69], v[102:103]
    v_pk_mul_f32 v[98:99], v[96:97], v[98:99]
    v_pk_mul_f32 v[102:103], v[100:101], v[102:103]
    v_pk_fma_f32 v[96:97], v[66:67], v[96:97], v[60:61]
    v_pk_fma_f32 v[100:101], v[70:71], v[100:101], v[62:63]
    s_mov_b64 exec, s[82:83]
    buffer_load_dword v64, v112, s[48:51], 0 offen offset:0 sc1
    buffer_load_dword v65, v120, s[48:51], 0 offen offset:0 sc1
    buffer_load_dword v66, v113, s[48:51], 0 offen offset:0 sc1
    buffer_load_dword v67, v121, s[48:51], 0 offen offset:0 sc1
    buffer_load_dword v68, v114, s[48:51], 0 offen offset:0 sc1
    buffer_load_dword v69, v122, s[48:51], 0 offen offset:0 sc1
    buffer_load_dword v70, v115, s[48:51], 0 offen offset:0 sc1
    buffer_load_dword v71, v123, s[48:51], 0 offen offset:0 sc1
    s_mov_b64 exec, -1
    v_pk_mul_f32 v[60:61], v[72:73], v[106:107]
    v_pk_mul_f32 v[62:63], v[76:77], v[110:111]
    v_pk_mul_f32 v[106:107], v[104:105], v[106:107]
    v_pk_mul_f32 v[110:111], v[108:109], v[110:111]
    v_pk_fma_f32 v[104:105], v[74:75], v[104:105], v[60:61]
    v_pk_fma_f32 v[108:109], v[78:79], v[108:109], v[62:63]
    s_mov_b64 exec, s[82:83]
    buffer_load_dword v72, v116, s[48:51], 0 offen offset:0 sc1
    buffer_load_dword v73, v124, s[48:51], 0 offen offset:0 sc1
    buffer_load_dword v74, v117, s[48:51], 0 offen offset:0 sc1
    buffer_load_dword v75, v125, s[48:51], 0 offen offset:0 sc1
    buffer_load_dword v76, v118, s[48:51], 0 offen offset:0 sc1
    buffer_load_dword v77, v126, s[48:51], 0 offen offset:0 sc1
    buffer_load_dword v78, v119, s[48:51], 0 offen offset:0 sc1
    buffer_load_dword v79, v127, s[48:51], 0 offen offset:0 sc1
    s_mov_b64 exec, -1
    v_pk_mul_f32 v[42:43], v[96:97], v[102:103]
    v_pk_mul_f32 v[46:47], v[104:105], v[110:111]
    v_pk_mul_f32 v[40:41], v[98:99], v[102:103]
    v_pk_mul_f32 v[44:45], v[106:107], v[110:111]
    v_pk_fma_f32 v[42:43], v[100:101], v[98:99], v[42:43]
    v_pk_fma_f32 v[46:47], v[108:109], v[106:107], v[46:47]
    s_cmp_eq_u32 s74, 2
    s_cbranch_scc0 L_PRm1_1
    s_setprio 1
L_PRm1_1:
    s_cmp_eq_u32 s74, 1
    s_cbranch_scc0 L_PRm1_0
    s_setprio 0
L_PRm1_0:
    s_waitcnt vmcnt(16)
    v_mfma_f32_32x32x16_bf16 v[96:111], v[56:59], v[52:55], v[80:95]
    v_rcp_f32 v40, v40
    v_rcp_f32 v41, v41
    v_rcp_f32 v44, v44
    v_rcp_f32 v45, v45
    ds_read_b64 v[56:57], v14 offset:128
    ds_read_b32 v54, v10 offset:4
    ds_read_b32 v55, v11 offset:4
    v_lshlrev_b32 v80, 16, v80
    v_lshlrev_b32 v81, 16, v81
    v_lshlrev_b32 v82, 16, v82
    v_lshlrev_b32 v83, 16, v83
    v_lshlrev_b32 v84, 16, v84
    v_lshlrev_b32 v85, 16, v85
    v_lshlrev_b32 v86, 16, v86
    v_lshlrev_b32 v87, 16, v87
    v_pk_fma_f32 v[2:3], v[42:43], v[40:41], v[2:3]
    v_exp_f32 v96, v96 clamp
    v_pk_fma_f32 v[2:3], v[46:47], v[44:45], v[2:3]
    v_lshlrev_b32 v88, 16, v88
    v_exp_f32 v97, v97 clamp
    v_lshlrev_b32 v89, 16, v89
    v_exp_f32 v98, v98 clamp
    v_lshlrev_b32 v90, 16, v90
    v_exp_f32 v99, v99 clamp
    v_lshlrev_b32 v91, 16, v91
    v_exp_f32 v100, v100 clamp
    v_lshlrev_b32 v92, 16, v92
    v_exp_f32 v101, v101 clamp
    v_lshlrev_b32 v93, 16, v93
    v_exp_f32 v102, v102 clamp
    v_lshlrev_b32 v94, 16, v94
    v_exp_f32 v103, v103 clamp
    v_lshlrev_b32 v95, 16, v95
    v_exp_f32 v104, v104 clamp
    v_exp_f32 v105, v105 clamp
    v_exp_f32 v106, v106 clamp
    v_exp_f32 v107, v107 clamp
    v_exp_f32 v108, v108 clamp
    v_exp_f32 v109, v109 clamp
    v_exp_f32 v110, v110 clamp
    v_exp_f32 v111, v111 clamp
    v_pk_add_f32 v[96:97], v[96:97], s[78:79]
    v_pk_add_f32 v[98:99], v[98:99], s[78:79]
    v_pk_add_f32 v[100:101], v[100:101], s[78:79]
    v_pk_add_f32 v[102:103], v[102:103], s[78:79]
    v_pk_add_f32 v[104:105], v[104:105], s[78:79]
    v_pk_add_f32 v[106:107], v[106:107], s[78:79]
    v_pk_add_f32 v[108:109], v[108:109], s[78:79]
    v_pk_add_f32 v[110:111], v[110:111], s[78:79]
    v_pk_mul_f32 v[60:61], v[80:81], v[98:99]
    v_pk_mul_f32 v[62:63], v[84:85], v[102:103]
    v_pk_mul_f32 v[98:99], v[96:97], v[98:99]
    v_pk_mul_f32 v[102:103], v[100:101], v[102:103]
    v_pk_fma_f32 v[96:97], v[82:83], v[96:97], v[60:61]
    v_pk_fma_f32 v[100:101], v[86:87], v[100:101], v[62:63]
    s_mov_b64 exec, s[82:83]
    buffer_load_dword v80, v112, s[48:51], 0 offen offset:4 sc1
    buffer_load_dword v81, v120, s[48:51], 0 offen offset:4 sc1
    buffer_load_dword v82, v113, s[48:51], 0 offen offset:4 sc1
    buffer_load_dword v83, v121, s[48:51], 0 offen offset:4 sc1
    buffer_load_dword v84, v114, s[48:51], 0 offen offset:4 sc1
    buffer_load_dword v85, v122, s[48:51], 0 offen offset:4 sc1
    buffer_load_dword v86, v115, s[48:51], 0 offen offset:4 sc1
    buffer_load_dword v87, v123, s[48:51], 0 offen offset:4 sc1
    s_mov_b64 exec, -1
    v_pk_mul_f32 v[60:61], v[88:89], v[106:107]
    v_pk_mul_f32 v[62:63], v[92:93], v[110:111]
    v_pk_mul_f32 v[106:107], v[104:105], v[106:107]
    v_pk_mul_f32 v[110:111], v[108:109], v[110:111]
    v_pk_fma_f32 v[104:105], v[90:91], v[104:105], v[60:61]
    v_pk_fma_f32 v[108:109], v[94:95], v[108:109], v[62:63]
    s_mov_b64 exec, s[82:83]
    buffer_load_dword v88, v116, s[48:51], 0 offen offset:4 sc1
    buffer_load_dword v89, v124, s[48:51], 0 offen offset:4 sc1
    buffer_load_dword v90, v117, s[48:51], 0 offen offset:4 sc1
    buffer_load_dword v91, v125, s[48:51], 0 offen offset:4 sc1
    buffer_load_dword v92, v118, s[48:51], 0 offen offset:4 sc1
    buffer_load_dword v93, v126, s[48:51], 0 offen offset:4 sc1
    buffer_load_dword v94, v119, s[48:51], 0 offen offset:4 sc1
    buffer_load_dword v95, v127, s[48:51], 0 offen offset:4 sc1
    s_mov_b64 exec, -1
    ds_read_b128 v[112:115], v12 offset:96
    ds_read_b128 v[116:119], v12 offset:112
    ds_read_b128 v[120:123], v13 offset:96
    ds_read_b128 v[124:127], v13 offset:112
    v_pk_mul_f32 v[42:43], v[96:97], v[102:103]
    v_pk_mul_f32 v[46:47], v[104:105], v[110:111]
    v_pk_mul_f32 v[40:41], v[98:99], v[102:103]
    v_pk_mul_f32 v[44:45], v[106:107], v[110:111]
    v_pk_fma_f32 v[42:43], v[100:101], v[98:99], v[42:43]
    v_pk_fma_f32 v[46:47], v[108:109], v[106:107], v[46:47]
    s_sub_u32 s74, s74, 1
    s_cmp_eq_u32 s74, 0
    s_cbranch_scc1 L_FIN1
    s_cmp_eq_u32 s74, 1
    s_cselect_b64 s[82:83], 0, -1
    s_cmp_eq_u32 s74, 3
    s_cbranch_scc0 L_PR1_2
    s_setprio 2
L_PR1_2:
    s_waitcnt vmcnt(16)
    s_waitcnt lgkmcnt(6)
    v_mfma_f32_32x32x16_bf16 v[96:111], v[56:59], v[48:51], v[64:79]
    v_rcp_f32 v40, v40
    v_rcp_f32 v41, v41
    v_rcp_f32 v44, v44
    v_rcp_f32 v45, v45
    ds_read_b64 v[10:11], v15 offset:768
    s_nop 1
    v_lshlrev_b32 v64, 16, v64
    v_lshlrev_b32 v65, 16, v65
    v_lshlrev_b32 v66, 16, v66
    v_lshlrev_b32 v67, 16, v67
    v_lshlrev_b32 v68, 16, v68
    v_lshlrev_b32 v69, 16, v69
    v_lshlrev_b32 v70, 16, v70
    v_lshlrev_b32 v71, 16, v71
    v_pk_fma_f32 v[4:5], v[42:43], v[40:41], v[4:5]
    v_exp_f32 v96, v96 clamp
    v_pk_fma_f32 v[4:5], v[46:47], v[44:45], v[4:5]
    v_lshlrev_b32 v72, 16, v72
    ds_write2_b32 v8, v2, v4 offset0:0 offset1:1
    ds_write2_b32 v9, v3, v5 offset0:0 offset1:1
    ds_read_b32 v2, v6
    ds_read_b32 v3, v7
    ds_read_b32 v4, v6 offset:4
    ds_read_b32 v5, v7 offset:4
    ds_read_b64 v[8:9], v15 offset:25600
    v_exp_f32 v97, v97 clamp
    v_lshlrev_b32 v73, 16, v73
    v_exp_f32 v98, v98 clamp
    v_lshlrev_b32 v74, 16, v74
    v_exp_f32 v99, v99 clamp
    v_lshlrev_b32 v75, 16, v75
    v_exp_f32 v100, v100 clamp
    v_lshlrev_b32 v76, 16, v76
    v_exp_f32 v101, v101 clamp
    v_lshlrev_b32 v77, 16, v77
    v_exp_f32 v102, v102 clamp
    v_lshlrev_b32 v78, 16, v78
    v_exp_f32 v103, v103 clamp
    v_lshlrev_b32 v79, 16, v79
    v_exp_f32 v104, v104 clamp
    v_exp_f32 v105, v105 clamp
    v_exp_f32 v106, v106 clamp
    v_exp_f32 v107, v107 clamp
    s_waitcnt lgkmcnt(0)
    v_lshl_add_u64 v[10:11], v[10:11], 0, v[28:29]
    v_lshl_add_u64 v[8:9], v[8:9], 0, v[26:27]
    ds_read_b32 v50, v10
    ds_read_b32 v51, v11
    v_exp_f32 v108, v108 clamp
    v_exp_f32 v109, v109 clamp
    v_exp_f32 v110, v110 clamp
    v_exp_f32 v111, v111 clamp
    v_pk_add_f32 v[96:97], v[96:97], s[78:79]
    v_pk_add_f32 v[98:99], v[98:99], s[78:79]
    v_pk_add_f32 v[100:101], v[100:101], s[78:79]
    v_pk_add_f32 v[102:103], v[102:103], s[78:79]
    v_pk_add_f32 v[104:105], v[104:105], s[78:79]
    v_pk_add_f32 v[106:107], v[106:107], s[78:79]
    v_pk_add_f32 v[108:109], v[108:109], s[78:79]
    v_pk_add_f32 v[110:111], v[110:111], s[78:79]
    v_pk_mul_f32 v[60:61], v[64:65], v[98:99]
    v_pk_mul_f32 v[62:63], v[68:69], v[102:103]
    v_pk_mul_f32 v[98:99], v[96:97], v[98:99]
    v_pk_mul_f32 v[102:103], v[100:101], v[102:103]
    v_pk_fma_f32 v[96:97], v[66:67], v[96:97], v[60:61]
    v_pk_fma_f32 v[100:101], v[70:71], v[100:101], v[62:63]
    s_mov_b64 exec, s[82:83]
    buffer_load_dword v64, v112, s[48:51], 0 offen offset:0 sc1
    buffer_load_dword v65, v120, s[48:51], 0 offen offset:0 sc1
    buffer_load_dword v66, v113, s[48:51], 0 offen offset:0 sc1
    buffer_load_dword v67, v121, s[48:51], 0 offen offset:0 sc1
    buffer_load_dword v68, v114, s[48:51], 0 offen offset:0 sc1
    buffer_load_dword v69, v122, s[48:51], 0 offen offset:0 sc1
    buffer_load_dword v70, v115, s[48:51], 0 offen offset:0 sc1
    buffer_load_dword v71, v123, s[48:51], 0 offen offset:0 sc1
    s_mov_b64 exec, -1
    v_pk_mul_f32 v[60:61], v[72:73], v[106:107]
    v_pk_mul_f32 v[62:63], v[76:77], v[110:111]
    v_pk_mul_f32 v[106:107], v[104:105], v[106:107]
    v_pk_mul_f32 v[110:111], v[108:109], v[110:111]
    v_pk_fma_f32 v[104:105], v[74:75], v[104:105], v[60:61]
    v_pk_fma_f32 v[108:109], v[78:79], v[108:109], v[62:63]
    s_mov_b64 exec, s[82:83]
    buffer_load_dword v72, v116, s[48:51], 0 offen offset:0 sc1
    buffer_load_dword v73, v124, s[48:51], 0 offen offset:0 sc1
    buffer_load_dword v74, v117, s[48:51], 0 offen offset:0 sc1
    buffer_load_dword v75, v125, s[48:51], 0 offen offset:0 sc1
    buffer_load_dword v76, v118, s[48:51], 0 offen offset:0 sc1
    buffer_load_dword v77, v126, s[48:51], 0 offen offset:0 sc1
    buffer_load_dword v78, v119, s[48:51], 0 offen offset:0 sc1
    buffer_load_dword v79, v127, s[48:51], 0 offen offset:0 sc1
    s_mov_b64 exec, -1
    v_pk_mul_f32 v[42:43], v[96:97], v[102:103]
    v_pk_mul_f32 v[46:47], v[104:105], v[110:111]
    v_pk_mul_f32 v[40:41], v[98:99], v[102:103]
    v_pk_mul_f32 v[44:45], v[106:107], v[110:111]
    v_pk_fma_f32 v[42:43], v[100:101], v[98:99], v[42:43]
    v_pk_fma_f32 v[46:47], v[108:109], v[106:107], v[46:47]
    v_lshl_add_u64 v[12:13], v[12:13], 0, s[88:89]
    v_lshl_add_u64 v[14:15], v[14:15], 0, s[90:91]
    s_branch L_LOOP
L_FIN0:
    v_rcp_f32 v40, v40
    v_rcp_f32 v41, v41
    v_rcp_f32 v44, v44
    v_rcp_f32 v45, v45
    s_waitcnt lgkmcnt(0)
    v_pk_fma_f32 v[4:5], v[42:43], v[40:41], v[4:5]
    v_pk_fma_f32 v[4:5], v[46:47], v[44:45], v[4:5]
    ds_write2_b32 v6, v2, v4 offset0:0 offset1:1
    ds_write2_b32 v7, v3, v5 offset0:0 offset1:1
    s_branch L_FOLD
L_FIN1:
    v_rcp_f32 v40, v40
    v_rcp_f32 v41, v41
    v_rcp_f32 v44, v44
    v_rcp_f32 v45, v45
    s_waitcnt lgkmcnt(0)
    v_pk_fma_f32 v[4:5], v[42:43], v[40:41], v[4:5]
    v_pk_fma_f32 v[4:5], v[46:47], v[44:45], v[4:5]
    ds_write2_b32 v8, v2, v4 offset0:0 offset1:1
    ds_write2_b32 v9, v3, v5 offset0:0 offset1:1
L_FOLD:
    v_lshrrev_b32 v26, 4, v0
    v_and_b32 v27, 15, v0
    v_lshlrev_b32 v32, 2, v27
    v_lshlrev_b32 v27, 4, v27
    v_lshl_add_u32 v28, v26, 8, v27
    v_add_u32 v28, 99328, v28
    v_add_u32 v27, 67840, v27
    v_lshlrev_b32 v29, 2, v26
    s_mul_i32 s88, s3, 6272
    v_lshl_add_u32 v32, v26, 7, v32
    v_add_u32 v32, s88, v32
    v_mov_b32 v33, 0
    ds_read_b32 v30, v29 offset:56832
    ds_read_b32 v31, v29 offset:57088
    s_mov_b32 s86, 0x21000000
    s_mov_b32 s87, 0xa138aa3b
    v_cmp_gt_u32 vcc, 784, v0
    s_waitcnt vmcnt(0) lgkmcnt(0)
    s_barrier
    s_and_saveexec_b64 s[80:81], vcc
    s_cbranch_execz L_FDONE
    ds_read_b128 v[64:67], v28
    s_mov_b64 s[84:85], exec
L_FLOOP:
    v_cmp_lt_u32 vcc, v30, v31
    s_and_b64 exec, exec, vcc
    s_cbranch_execz L_FLEND
    v_add_u32 v30, 1, v30
    v_lshl_add_u32 v33, v30, 8, v27
    ds_read_b128 v[72:75], v33
    s_waitcnt lgkmcnt(0)
    v_add_f32 v64, v64, v72
    v_add_f32 v65, v65, v73
    v_add_f32 v66, v66, v74
    v_add_f32 v67, v67, v75
    s_branch L_FLOOP
L_FLEND:
    s_mov_b64 exec, s[84:85]
    s_waitcnt lgkmcnt(0)
    s_cmp_lg_u32 s77, 0
    s_cbranch_scc1 L_WB
    v_mul_f32 v72, s87, v64
    v_mul_f32 v73, s87, v65
    v_mul_f32 v74, s87, v66
    v_mul_f32 v75, s87, v67
    v_exp_f32 v72, v72
    v_exp_f32 v73, v73
    v_exp_f32 v74, v74
    v_exp_f32 v75, v75
    v_mul_f32 v64, s86, v64
    v_mul_f32 v65, s86, v65
    v_mul_f32 v66, s86, v66
    v_mul_f32 v67, s86, v67
    v_add_f32 v72, 1.0, v72
    v_add_f32 v73, 1.0, v73
    v_add_f32 v74, 1.0, v74
    v_add_f32 v75, 1.0, v75
    v_rcp_f32 v72, v72
    v_rcp_f32 v73, v73
    v_rcp_f32 v74, v74
    v_rcp_f32 v75, v75
    s_nop 0
    v_mul_f32 v64, v64, v72
    v_mul_f32 v65, v65, v73
    v_mul_f32 v66, v66, v74
    v_mul_f32 v67, v67, v75
    v_cvt_pk_bf16_f32 v80, v64, v66
    v_cvt_pk_bf16_f32 v81, v65, v67
    buffer_store_dword v80, v32, s[52:55], 0 offen nt
    buffer_store_dword v81, v32, s[52:55], 0 offen offset:64 nt
    s_endpgm
L_WB:
    ds_write_b128 v28, v[64:67]
L_FDONE:
    s_mov_b64 exec, -1
    s_cmp_eq_u32 s77, 0
    s_cbranch_scc1 L_QUIT
    s_add_u32 s75, s75, s76
    s_branch L_REFILL
L_OVERFLOW:
    s_mov_b32 s76, 64
L_REFILL:
    s_waitcnt vmcnt(0) lgkmcnt(0)
    s_barrier
    v_lshlrev_b32 v26, 4, v0
    v_mov_b32 v28, 0
    v_mov_b32 v29, 0
    v_mov_b32 v30, 0
    v_mov_b32 v31, 0
    v_add_u32 v27, 18688, v26
    ds_write_b128 v27, v[28:31] offset:0
    ds_write_b128 v27, v[28:31] offset:16384
    ds_write_b128 v27, v[28:31] offset:32768
    ds_write_b128 v27, v[28:31] offset:49152
    v_and_b32 v32, 15, v0
    v_lshlrev_b32 v32, 10, v32
    v_add_u32 v32, 67840, v32
    v_add_u32 v33, 256, v32
    v_add_u32 v34, 512, v32
    v_add_u32 v35, 768, v32
    v_add_u32 v27, 84224, v26
    v_cmp_gt_u32 vcc, 160, v0
    s_and_saveexec_b64 s[80:81], vcc
    ds_write_b128 v27, v[32:35]
    s_mov_b64 exec, s[80:81]
    v_lshlrev_b32 v26, 4, v0
    v_and_b32 v28, 7, v0
    v_lshlrev_b32 v28, 5, v28
    v_add_u32 v28, 100000, v28
    v_add_u32 v29, 8, v28
    v_add_u32 v30, 16, v28
    v_add_u32 v31, 24, v28
    ds_write_b128 v26, v[28:31] offset:0
    v_cmp_gt_u32 vcc, 144, v0
    s_and_saveexec_b64 s[80:81], vcc
    ds_write_b128 v26, v[28:31] offset:16384
    s_mov_b64 exec, s[80:81]
    v_lshrrev_b32 v13, 5, v1
    s_lshl_b32 s84, s72, 4
    s_add_u32 s84, s84, 59392
    v_lshlrev_b32 v15, 3, v13
    v_add_u32 v13, v13, v13
    v_add_u32 v15, s84, v15
    v_bfe_u32 v10, v1, 2, 1
    v_and_b32 v14, 1, v1
    v_lshl_or_b32 v10, v10, 1, v14
    v_bfe_u32 v14, v1, 3, 2
    v_bfe_u32 v12, v1, 1, 1
    v_lshl_or_b32 v14, v14, 1, v12
    v_lshlrev_b32 v14, 3, v14
    v_add_u32 v14, 18688, v14
    s_waitcnt lgkmcnt(0)
    s_barrier
    s_branch L_PASS
L_QUIT:
L_END:
    s_endpgm
.section .rodata,"a"
.p2align 6
.amdhsa_kernel standalone__edge_featured_mpnn_egc__graph_kernel
  .amdhsa_next_free_vgpr 128
  .amdhsa_next_free_sgpr 102
  .amdhsa_accum_offset 128
  .amdhsa_group_segment_fixed_size 0
  .amdhsa_kernarg_size 80
  .amdhsa_user_sgpr_count 2
  .amdhsa_user_sgpr_kernarg_segment_ptr 1
  .amdhsa_system_sgpr_workgroup_id_x 1
  .amdhsa_float_denorm_mode_32 3
.end_amdhsa_kernel
```
